```python
import torch

def _softmax(x, axis=-1):
    return torch.softmax(x, dim=axis)
def _gelu(x):
    return torch.nn.functional.gelu(x, approximate="tanh")
def _silu(x):
    return torch.nn.functional.silu(x)
def _sigmoid(x):
    return torch.sigmoid(x)
def _layernorm(x, axis=-1, eps=1e-5):
    m = x.mean(dim=axis, keepdim=True)
    v = x.var(dim=axis, keepdim=True, unbiased=False)
    return (x - m) / torch.sqrt(v + eps)
def _scatter_add(tgt, idx, src, axis=0):
    return tgt.clone().index_add_(axis, idx, src)
def _segment_sum(src, seg, n):
    out = torch.zeros((n,) + src.shape[1:], dtype=src.dtype)
    return out.index_add_(0, seg, src)
def _pad(x, pw):
    flat = tuple(v for pair in reversed(pw) for v in pair)
    return torch.nn.functional.pad(x, flat)

kernel_name = 'recurrent_scan__ssm_conv_s4__mixer_channel_mlp__prompt'

def setup_inputs():

    _w = (lambda a: (lambda t: t.to(torch.bfloat16) if t.is_floating_point() else t)(torch.as_tensor(a)))
    def _A_setup():
        B, L, D, N = 1, 2048, 640, 192
        A_re = -(lambda _x: torch.exp(torch.as_tensor(_x)))((lambda *s: torch.randn(*s, dtype=torch.bfloat16) * 3.2)(D, N))
        A_im = torch.pi * (lambda *s: torch.randn(*s, dtype=torch.bfloat16) * 0.05)(D, N)
        B_re = (lambda *s: torch.randn(*s, dtype=torch.bfloat16) * 0.1)(D, N)
        B_im = (lambda *s: torch.randn(*s, dtype=torch.bfloat16) * 0.1)(D, N)
        C_re = (lambda *s: torch.randn(*s, dtype=torch.bfloat16) * 0.1)(D, N)
        C_im = (lambda *s: torch.randn(*s, dtype=torch.bfloat16) * 0.1)(D, N)
        log_dt = (lambda *s: torch.randn(*s, dtype=torch.bfloat16) * 0.05)(D) * 0.5 - 4.0
        Dskip = (lambda *s: torch.randn(*s, dtype=torch.bfloat16) * 0.05)(D)
        return {
            "u": _w((lambda *s: torch.randn(*s, dtype=torch.bfloat16) * 0.05)(B, L, D)),
            "A_re": _w(A_re),
            "A_im": _w(A_im),
            "B_re": _w(B_re),
            "B_im": _w(B_im),
            "C_re": _w(C_re),
            "C_im": _w(C_im),
            "log_dt": _w(log_dt),
            "Dskip": _w(Dskip),
        }
    _A_in = _A_setup()

    def _B_setup():
        B, S, D, F = 1, 2048, 640, 1536
        return {
            "x": _w((lambda *s: torch.randn(*s, dtype=torch.bfloat16) * 0.05)(B, S, D)),
            "w1": _w((lambda *s: torch.randn(*s, dtype=torch.bfloat16) * 3.2)(D, F) * (D ** -0.5)),
            "b1": _w((lambda *s: torch.randn(*s, dtype=torch.bfloat16) * 1.6)(F)),
            "w2": _w((lambda *s: torch.randn(*s, dtype=torch.bfloat16) * 0.05)(F, D) * (F ** -0.5)),
            "b2": _w((lambda *s: torch.randn(*s, dtype=torch.bfloat16) * 0.1)(D)),
        }
    _B_in = _B_setup()

    return {
        "A_u": _A_in["u"],
        "A_A_re": _A_in["A_re"],
        "A_A_im": _A_in["A_im"],
        "A_B_re": _A_in["B_re"],
        "A_B_im": _A_in["B_im"],
        "A_C_re": _A_in["C_re"],
        "A_C_im": _A_in["C_im"],
        "A_log_dt": _A_in["log_dt"],
        "A_Dskip": _A_in["Dskip"],
        "B_x": _B_in["x"],
        "B_w1": _B_in["w1"],
        "B_b1": _B_in["b1"],
        "B_w2": _B_in["w2"],
        "B_b2": _B_in["b2"],
    }

def reference(A_u, A_A_re, A_A_im, A_B_re, A_B_im, A_C_re, A_C_im, A_log_dt, A_Dskip, B_x, B_w1, B_b1, B_w2, B_b2):
    def _A_ref(u, A_re, A_im, B_re, B_im, C_re, C_im, log_dt, Dskip):
        Bsz, L, D = u.shape
        dt = torch.exp(log_dt)[:, None]
        A = A_re + 1j * A_im
        Bc = B_re + 1j * B_im
        Cc = C_re + 1j * C_im
        logdA = dt * A
        dB = dt * Bc
        l = (lambda x, dt: x.to(dt))(torch.arange(L), A_re.dtype)
        P = torch.exp(logdA[:, :, None] * l[None, None, :])
        K = torch.einsum("dn,dnl,dn->dl", Cc, P, dB).real
        L2 = 2 * L
        Kp = _pad(K, ((0, 0), (0, L)))
        up = (lambda x, *d: x.permute(*d))(u, 0, 2, 1)
        up = _pad(up, ((0, 0), (0, 0), (0, L)))
        Kf = (lambda x, axes=(-2,-1): torch.fft.rfft2(x.float(), dim=axes))(Kp[:, None, :], axes=(-2, -1))
        Uf = (lambda x, axes=(-2,-1): torch.fft.rfft2(x.float(), dim=axes))(up[:, :, None, :], axes=(-2, -1))
        Yf = Uf * Kf[None, :, :, :]
        y = (lambda x, s, axes=(-2,-1): torch.fft.irfft2(x, s=s, dim=axes).to(torch.bfloat16))(Yf, (1, L2), axes=(-2, -1))[:, :, 0, :L]
        y = (lambda x, *d: x.permute(*d))(y, 0, 2, 1) + u * Dskip[None, None, :]
        return y

    def _B_ref(x, w1, b1, w2, b2):
        y = _layernorm(x, axis=-1)
        h = _gelu(torch.einsum("bsd,df->bsf", y, w1) + b1)
        return torch.einsum("bsf,fd->bsd", h, w2) + b2

    x = A_u
    xn = _layernorm(x, axis=-1)
    s = _A_ref(xn, A_A_re, A_A_im, A_B_re, A_B_im, A_C_re, A_C_im, A_log_dt, A_Dskip)
    g = _silu(_B_ref(xn, B_w1, B_b1, B_w2, B_b2))
    return x + s * g
```

```asm
; @launch grid=(256,1,1) block=(256,1,1) lds=163840
.amdgcn_target "amdgcn-amd-amdhsa--gfx950"
.text
.globl recurrent_scan__ssm_conv_s4__mixer_channel_mlp__prompt_kernel
.p2align 8
.type recurrent_scan__ssm_conv_s4__mixer_channel_mlp__prompt_kernel,@function
recurrent_scan__ssm_conv_s4__mixer_channel_mlp__prompt_kernel:
    s_load_dwordx16 s[16:31], s[0:1], 0
    s_load_dwordx16 s[32:47], s[0:1], 64
    s_load_dwordx2 s[48:49], s[0:1], 128
    s_cmp_ge_u32 s2, 256
    s_cbranch_scc1 L_end
    s_getpc_b64 s[72:73]
L_pc:
    v_lshrrev_b32 v1, 6, v0
    s_lshr_b32 s5, s2, 3
    v_and_b32_e64 v0, 63, v0
    s_lshl_b32 s7, s5, 4
    v_lshl_add_u32 v8, v1, 2, v0
    v_readfirstlane_b32 s3, v1
    v_add_lshl_u32 v8, v8, s7, 7
    v_min_u32 v8, L_code_end-L_pc-4, v8
    s_mov_b64 exec, 15
    global_load_dword v248, v8, s[72:73]
    s_mov_b64 exec, -1
    s_and_b32 s4, s2, 7
    s_lshl_b32 s6, s4, 5
    s_add_u32 s6, s6, s5
    v_lshrrev_b32_e64 v4, 5, v0
    v_and_b32 v5, 31, v0
    v_mul_u32_u24 v7, 1280, v4
    v_lshl_add_u32 v7, v5, 3, v7
    s_lshl_b32 s72, s6, 2
    s_add_u32 s72, s72, s3
    s_mul_i32 s72, s72, 2560
    s_mov_b32 s54, 2621440
    s_mov_b32 s55, 0x20000
    s_mul_i32 s7, s5, 43
    s_lshr_b32 s7, s7, 7
    s_mul_i32 s10, s5, 3
    s_sub_u32 s10, s10, s7
    s_or_b32 s11, s10, 7
    s_add_u32 s7, s10, s3
    s_min_u32 s11, s11, s7
    s_min_u32 s11, s11, 79
    s_mul_i32 s7, s4, 80
    s_add_u32 s10, s10, s7
    s_add_u32 s11, s11, s7
    s_waitcnt lgkmcnt(0)
    s_mov_b64 s[52:53], s[16:17]
    buffer_load_dwordx2 v[110:111], v7, s[52:55], s72 offen offset:0
    buffer_load_dwordx2 v[112:113], v7, s[52:55], s72 offen offset:256
    buffer_load_dwordx2 v[114:115], v7, s[52:55], s72 offen offset:512
    buffer_load_dwordx2 v[116:117], v7, s[52:55], s72 offen offset:768
    buffer_load_dwordx2 v[118:119], v7, s[52:55], s72 offen offset:1024
    s_mov_b64 s[68:69], s[48:49]
    s_mov_b32 s70, 18350080
    s_mov_b32 s71, 0x20000
    s_mov_b32 s73, 16777216
    v_mov_b32 v211, 34304
    v_mov_b64 v[40:41], 0
    v_mov_b64 v[42:43], 0
    buffer_load_dword v109, off, s[68:71], s73 sc1
    s_mov_b64 exec, 1
    ds_write_b128 v211, v[40:43]
    s_mov_b64 exec, -1
    v_lshrrev_b32 v2, 4, v0
    v_and_b32 v3, 15, v0
    s_lshr_b32 s9, s5, 3
    s_and_b32 s7, s4, 3
    s_lshl_b32 s7, s7, 2
    s_add_u32 s9, s9, s7
    s_and_b32 s7, s9, 1
    s_mul_i32 s90, s9, 192
    s_add_u32 s91, s90, 128
    s_lshl_b32 s74, s7, 6
    s_add_u32 s90, s90, s74
    s_lshl_b32 s74, s7, 7
    s_sub_u32 s91, s91, s74
    s_mov_b64 s[56:57], s[36:37]
    s_mov_b32 s58, 1966080
    s_mov_b32 s59, 0x20000
    s_mov_b64 s[60:61], s[40:41]
    s_mov_b32 s62, 1966080
    s_mov_b32 s63, 0x20000
    s_bitcmp1_b32 s5, 2
    s_cselect_b32 s87, 3, 13
    s_lshl_b32 s87, s87, 12
    s_add_u32 s87, s87, 40960
    s_waitcnt lgkmcnt(0)
    s_barrier
    s_cmp_eq_u32 s3, 3
    s_cbranch_scc1 L_st3
    s_mul_i32 s7, s11, 384
    v_lshl_add_u32 v8, v0, 1, s7
    s_lshl_b32 s7, s11, 1
    v_mov_b32 v6, s7
    v_mov_b64 v[10:11], 0
    v_mov_b64 v[12:13], 0
    v_mov_b64 v[14:15], 0
    v_mov_b64 v[16:17], 0
    v_mov_b64 v[18:19], 0
    v_mov_b64 v[20:21], 0
    v_mov_b64 v[22:23], 0
    v_mov_b64 v[24:25], 0
    v_mov_b64 v[26:27], 0
    v_mov_b64 v[28:29], 0
    v_mov_b64 v[44:45], 0
    v_mov_b64 v[196:197], 0
    global_load_short_d16_hi v28, v6, s[30:31]
    global_load_short_d16_hi v29, v6, s[32:33]
    global_load_short_d16_hi v10, v8, s[18:19] offset:0
    global_load_short_d16_hi v11, v8, s[20:21] offset:0
    global_load_short_d16_hi v12, v8, s[22:23] offset:0
    global_load_short_d16_hi v13, v8, s[24:25] offset:0
    global_load_short_d16_hi v14, v8, s[26:27] offset:0
    global_load_short_d16_hi v15, v8, s[28:29] offset:0
    global_load_short_d16_hi v16, v8, s[18:19] offset:128
    global_load_short_d16_hi v17, v8, s[20:21] offset:128
    global_load_short_d16_hi v18, v8, s[22:23] offset:128
    global_load_short_d16_hi v19, v8, s[24:25] offset:128
    global_load_short_d16_hi v20, v8, s[26:27] offset:128
    global_load_short_d16_hi v21, v8, s[28:29] offset:128
    global_load_short_d16_hi v22, v8, s[18:19] offset:256
    global_load_short_d16_hi v23, v8, s[20:21] offset:256
    global_load_short_d16_hi v24, v8, s[22:23] offset:256
    global_load_short_d16_hi v25, v8, s[24:25] offset:256
    global_load_short_d16_hi v26, v8, s[26:27] offset:256
    global_load_short_d16_hi v27, v8, s[28:29] offset:256
    v_lshl_add_u32 v30, v5, 1, s90
    v_lshl_add_u32 v31, v5, 1, s91
    v_mov_b64 v[240:241], 0
    v_mov_b64 v[242:243], 0
    v_mov_b64 v[244:245], 0
    v_mov_b64 v[246:247], 0
    s_mov_b64 exec, 0xffffffff
    global_load_ushort v240, v30, s[38:39]
    global_load_ushort v242, v30, s[38:39] offset:64
    global_load_ushort v244, v31, s[38:39]
    s_mov_b64 exec, -1
    s_branch L_stj
L_st3:
    v_lshl_add_u32 v30, v5, 1, s90
    v_lshl_add_u32 v31, v5, 1, s91
    v_mov_b64 v[240:241], 0
    v_mov_b64 v[242:243], 0
    v_mov_b64_e64 v[244:245], 0
    v_mov_b64 v[246:247], 0
    s_mov_b64 exec, 0xffffffff
    global_load_ushort v240, v30, s[38:39]
    global_load_ushort v242, v30, s[38:39] offset:64
    global_load_ushort v244, v31, s[38:39]
    s_mov_b64 exec, -1
    v_mul_u32_u24 v200, 1280, v2
    v_lshl_add_u32 v200, v3, 4, v200
    v_add_u32 v201, 4096, v200
    v_add_u32 v202, 4096, v201
    v_add_u32 v203, 4096, v202
    s_min_u32 s7, s2, 239
    s_mul_i32 s14, s7, 52429
    s_lshr_b32 s14, s14, 18
    s_mul_i32 s15, s14, 5
    s_sub_u32 s15, s7, s15
    s_mul_i32 s84, s14, 40960
    s_lshl_b32 s7, s15, 8
    s_add_u32 s84, s84, s7
    v_lshrrev_b32 v6, 3, v0
    v_mul_u32_u24 v40, 3072, v6
    v_lshrrev_b32 v7, 2, v0
    v_mul_u32_u24 v44, 3072, v7
    v_xor_b32 v8, v7, v2
    v_and_b32 v8, 1, v8
    v_lshl_add_u32 v40, v8, 6, v40
    v_and_b32 v8, 3, v0
    v_lshl_add_u32 v40, v8, 4, v40
    v_lshl_add_u32 v44, v8, 4, v44
    v_add_u32 v41, 23552, v40
    v_add_u32 v42, 23552, v41
    v_add_u32 v43, 23552, v42
    v_add_u32 v45, 48128, v44
    s_and_b32 s7, s5, 7
    s_mul_i32 s80, s7, 5
    s_lshr_b32 s80, s80, 1
    s_lshl_b32 s82, s80, 11
    s_mul_i32 s80, s80, 98304
    s_mov_b32 m0, 26112
    s_nop 0
    s_nop 0
    buffer_load_dwordx4 v200, s[60:63], s84 offen offset:0 lds
    buffer_load_dwordx4 v201, s[60:63], s84 offen offset:1024 lds
    buffer_load_dwordx4 v202, s[60:63], s84 offen offset:2048 lds
    buffer_load_dwordx4 v203, s[60:63], s84 offen offset:3072 lds
    s_mov_b32 m0, 30208
    s_add_u32 s84, s84, 20480
    buffer_load_dwordx4 v200, s[60:63], s84 offen offset:0 lds
    buffer_load_dwordx4 v201, s[60:63], s84 offen offset:1024 lds
    buffer_load_dwordx4 v202, s[60:63], s84 offen offset:2048 lds
    buffer_load_dwordx4 v203, s[60:63], s84 offen offset:3072 lds
    s_lshl_b32 s7, s82, 1
    s_add_u32 m0, s7, 40960
    s_add_u32 s7, s80, s90
    buffer_load_dwordx4 v40, s[56:59], s7 offen offset:0 lds
    buffer_load_dwordx4 v41, s[56:59], s7 offen offset:1024 lds
    buffer_load_dwordx4 v42, s[56:59], s7 offen offset:2048 lds
    buffer_load_dwordx4 v43, s[56:59], s7 offen offset:3072 lds
    s_add_u32 m0, s82, 122880
    s_add_u32 s7, s80, s91
    buffer_load_dwordx4 v44, s[56:59], s7 offen offset:0 lds
    s_nop 0
    buffer_load_dwordx4 v45, s[56:59], s7 offen offset:1024 lds
    s_add_u32 s82, s82, 2048
    s_add_u32 s80, s80, 98304
    s_cmp_eq_u32 s82, 40960
    s_cselect_b32 s82, 0, s82
    s_cselect_b32 s80, 0, s80
    s_lshl_b32 s7, s82, 1
    s_add_u32 m0, s7, 40960
    s_add_u32 s7, s80, s90
    buffer_load_dwordx4 v40, s[56:59], s7 offen offset:0 lds
    buffer_load_dwordx4 v41, s[56:59], s7 offen offset:1024 lds
    buffer_load_dwordx4 v42, s[56:59], s7 offen offset:2048 lds
    buffer_load_dwordx4 v43, s[56:59], s7 offen offset:3072 lds
    s_add_u32 m0, s82, 122880
    s_add_u32 s7, s80, s91
    s_nop 0
    buffer_load_dwordx4 v44, s[56:59], s7 offen offset:0 lds
    buffer_load_dwordx4 v45, s[56:59], s7 offen offset:1024 lds
    s_add_u32 s82, s82, 2048
    s_add_u32 s80, s80, 98304
    s_cmp_eq_u32 s82, 40960
    s_cselect_b32 s82, 0, s82
    s_cselect_b32 s80, 0, s80
    s_lshl_b32 s7, s82, 1
    s_add_u32 m0, s7, 40960
    s_add_u32 s7, s80, s90
    buffer_load_dwordx4 v40, s[56:59], s7 offen offset:0 lds
    buffer_load_dwordx4 v41, s[56:59], s7 offen offset:1024 lds
    buffer_load_dwordx4 v42, s[56:59], s7 offen offset:2048 lds
    buffer_load_dwordx4 v43, s[56:59], s7 offen offset:3072 lds
    s_add_u32 m0, s82, 122880
    s_add_u32 s7, s80, s91
    buffer_load_dwordx4 v44, s[56:59], s7 offen offset:0 lds
    s_nop 0
    buffer_load_dwordx4 v45, s[56:59], s7 offen offset:1024 lds
    s_add_u32 s82, s82, 2048
    s_add_u32 s80, s80, 98304
    s_cmp_eq_u32 s82, 40960
    s_cselect_b32 s82, 0, s82
    s_cselect_b32 s80, 0, s80
    v_min_u32_e64 v9, 9, v0
    v_lshlrev_b32 v9, 7, v9
    v_and_b32 v198, 7, v0
    v_mul_u32_u24 v196, 1312, v198
    global_load_dword v248, v9, s[42:43]
    v_lshl_add_u32 v196, v6, 4, v196
    v_add_u32 v196, s87, v196
    v_lshlrev_b32 v197, 9, v6
    v_lshl_add_u32 v197, v198, 4, v197
    v_lshlrev_b32 v199, 12, v4
    v_and_b32 v7, 7, v7
    v_lshl_add_u32 v199, v7, 8, v199
    v_lshl_add_u32 v199, v8, 3, v199
    s_mul_i32 s15, s15, 384
    s_add_u32 s14, s14, s15
    s_lshl_b32 s14, s14, 10
    s_add_u32 s14, s14, 5373952
    s_lshr_b32 s15, s6, 2
    s_mul_i32 s15, s15, 41472
    s_and_b32 s7, s6, 3
    s_lshl_b32 s7, s7, 7
    s_add_u32 s15, s15, s7
    s_lshr_b32 s85, s6, 4
    s_lshl_b32 s85, s85, 8
    s_and_b32 s7, s6, 15
    s_lshl_b32 s7, s7, 2
    s_add_u32 s85, s85, s7
    s_add_u32 s85, s85, 16785408
    s_lshl_b32 s81, s6, 8
    s_add_u32 s81, s81, 16842752
L_stj:
    s_mov_b64 s[64:65], s[44:45]
    s_mov_b32 s66, 2621440
    s_mov_b32 s67, 0x20000
    s_lshl_b32 s7, s3, 1
    v_add_u32_e64 v6, s7, v4
    v_mul_u32_u24 v204, 1312, v6
    v_lshl_add_u32 v6, v5, 3, s87
    v_add_u32 v204, v204, v6
    s_lshl_b32 s7, s3, 2
    v_add_u32 v205, s7, v211
    v_lshlrev_b32 v1, 4, v0
    s_mul_i32 s7, s3, 8704
    v_mul_u32_u24 v210, 272, v5
    v_lshl_add_u32 v6, v4, 4, s7
    v_add_u32_e64 v210, v210, v6
    s_mul_i32 s7, s3, 4352
    v_lshl_add_u32 v6, v4, 4, s7
    v_lshl_add_u32 v214, v5, 5, v6
    v_cmp_gt_u32 vcc, 32, v0
    v_lshl_add_u32 v6, v5, 4, s7
    v_lshl_add_u32 v7, v5, 3, s7
    v_add_u32 v8, 1024, v6
    v_add_u32 v9, 1536, v7
    v_cndmask_b32 v215, v9, v8, vcc
    v_add_u32 v8, 1032, v6
    v_add_u32 v9, 1792, v7
    v_cndmask_b32 v216, v9, v8, vcc
    v_sub_u32 v6, 63, v0
    v_lshl_add_u32 v217, v6, 3, s7
    v_lshl_add_u32 v218, v6, 4, s7
    v_lshl_add_u32 v219, v0, 5, s7
    v_lshl_add_u32 v220, v0, 4, s7
    v_lshl_add_u32 v221, v0, 3, s7
    s_lshl_b32 s7, s3, 10
    v_lshl_add_u32 v224, v0, 2, s7
    s_nop 0
    v_add_u32 v225, 4352, v224
    v_add_u32 v226, 8704, v224
    s_add_u32 s7, s7, 35232
    v_lshl_add_u32 v223, v0, 1, s7
    v_lshlrev_b32_e64 v233, 4, v5
    v_mul_u32_u24 v222, 41472, v4
    v_add_u32 v222, v222, v233
    v_and_b32 v6, 3, v0
    v_lshrrev_b32 v7, 2, v0
    v_lshlrev_b32 v208, 8, v7
    v_lshl_add_u32 v208, v6, 4, v208
    v_lshlrev_b32 v209, 8, v6
    s_min_u32 s7, s3, 2
    s_mul_i32 s7, s7, 21280
    s_add_u32 s74, s7, 22176
    s_add_u32 s7, s7, 34720
    v_lshl_add_u32 v228, v0, 3, s7
    v_sub_u32_e64 v8, v3, v4
    v_lshl_add_u32 v8, v8, 2, s74
    v_mul_u32_u24 v227, 4160, v2
    v_add_u32 v227, v227, v8
    v_and_b32 v8, 1, v2
    v_lshlrev_b32 v6, 3, v6
    v_lshl_add_u32 v6, v8, 5, v6
    v_and_b32 v7, 3, v7
    v_lshl_add_u32 v7, v4, 3, v7
    v_lshl_add_u32 v238, v7, 6, v6
    v_add_u32 v238, 122880, v238
    v_lshl_add_u32 v236, v7, 7, v6
    v_and_b32_e64 v7, 8, v0
    v_lshl_add_u32 v236, v7, 3, v236
    v_add_u32 v236, 40960, v236
    v_xor_b32_e64 v237, 64, v236
    v_mul_u32_u24 v239, 49152, v8
    v_lshl_add_u32 v239, v4, 8, v239
    v_lshl_add_u32 v239, v3, 4, v239
    s_cmp_eq_u32 s3, 3
    s_cselect_b32 s7, 0, s3
    s_mul_i32 s7, s7, 21280
    s_add_u32 s7, s7, 18080
    v_lshl_add_u32 v6, v2, 4, s7
    v_lshl_add_u32 v213, v3, 5, v6
    v_sub_u32_e64 v7, 15, v3
    v_and_b32 v8, 3, v7
    v_and_b32 v7, 12, v7
    v_lshl_add_u32 v6, v7, 1, v6
    v_mul_u32_u24 v212, 4160, v8
    v_add_u32 v212, v212, v6
    s_lshr_b32 s8, s4, 2
    s_lshl_b32 s8, s8, 3
    s_and_b32 s7, s5, 7
    s_add_u32 s8, s8, s7
    s_lshl_b32 s94, s8, 2
    s_add_u32 s94, s94, s3
    s_lshl_b32 s86, s94, 10
    s_add_u32 s86, s86, 16842752
    s_mul_i32 s92, s94, 96
    s_mul_i32 s94, s94, 41472
    s_add_u32 s83, s94, 40960
    s_mov_b32 s74, 0x3acccccd
    s_mov_b32 s75, 0x3727c5ac
    s_cmp_eq_u32 s3, 3
    s_cbranch_scc1 L_xw3
    s_waitcnt vmcnt(23)
    s_branch L_xwj
L_xw3:
    s_waitcnt vmcnt(30)
L_xwj:
    v_lshlrev_b32 v120, 16, v110
    v_and_b32 v121, 0xffff0000, v110
    v_lshlrev_b32 v122, 16, v111
    v_and_b32 v123, 0xffff0000, v111
    v_lshlrev_b32 v124, 16, v112
    v_and_b32 v125, 0xffff0000, v112
    v_lshlrev_b32 v126, 16, v113
    v_and_b32 v127, 0xffff0000, v113
    v_lshlrev_b32 v128, 16, v114
    v_and_b32 v129, 0xffff0000, v114
    v_lshlrev_b32 v130, 16, v115
    v_and_b32 v131, 0xffff0000, v115
    v_lshlrev_b32 v132, 16, v116
    v_and_b32 v133, 0xffff0000, v116
    v_lshlrev_b32 v134, 16, v117
    v_and_b32 v135, 0xffff0000, v117
    v_lshlrev_b32 v136, 16, v118
    v_and_b32 v137, 0xffff0000, v118
    v_lshlrev_b32_e64 v138, 16, v119
    v_and_b32 v139, 0xffff0000, v119
    v_pk_add_f32 v[140:141], v[120:121], v[122:123]
    v_pk_add_f32 v[140:141], v[140:141], v[124:125]
    v_pk_add_f32 v[140:141], v[140:141], v[126:127]
    v_pk_add_f32 v[140:141], v[140:141], v[128:129]
    v_pk_add_f32 v[140:141], v[140:141], v[130:131]
    v_pk_add_f32 v[140:141], v[140:141], v[132:133]
    v_pk_add_f32 v[140:141], v[140:141], v[134:135]
    v_pk_add_f32 v[140:141], v[140:141], v[136:137]
    v_pk_add_f32 v[140:141], v[140:141], v[138:139]
    v_add_f32_e64 v140, v140, v141
    v_readfirstlane_b32 s7, v109
    v_mov_b32 v147, 0
    v_add_f32_dpp v140, v140, v140 quad_perm:[1,0,3,2] row_mask:0xf bank_mask:0xf
    s_mul_i32 s7, s7, 1664525
    s_add_u32 s50, s7, 1013904223
    v_add_f32_dpp v140, v140, v140 quad_perm:[2,3,0,1] row_mask:0xf bank_mask:0xf
    s_mov_b32 s51, s50
    v_cmp_eq_u32 vcc, 0, v5
    v_add_f32_dpp v140, v140, v140 row_half_mirror row_mask:0xf bank_mask:0xf
    v_mov_b32 v6, 1
    s_mov_b32 s76, 3
    v_add_f32_dpp v140, v140, v140 row_mirror row_mask:0xf bank_mask:0xf
    s_mov_b32 s77, 3
    v_mov_b32 v141, v140
    s_nop 1
    v_permlane16_swap_b32 v140, v141
    v_add_f32 v140, v140, v141
    v_mul_f32 v142, s74, v140
    v_pk_add_f32 v[120:121], v[120:121], v[142:143] op_sel_hi:[1,0] neg_lo:[0,1] neg_hi:[0,1]
    v_pk_add_f32 v[122:123], v[122:123], v[142:143] op_sel_hi:[1,0] neg_lo:[0,1] neg_hi:[0,1]
    v_pk_add_f32 v[124:125], v[124:125], v[142:143] op_sel_hi:[1,0] neg_lo:[0,1] neg_hi:[0,1]
    v_pk_add_f32 v[126:127], v[126:127], v[142:143] op_sel_hi:[1,0] neg_lo:[0,1] neg_hi:[0,1]
    v_pk_add_f32 v[128:129], v[128:129], v[142:143] op_sel_hi:[1,0] neg_lo:[0,1] neg_hi:[0,1]
    v_pk_add_f32 v[130:131], v[130:131], v[142:143] op_sel_hi:[1,0] neg_lo:[0,1] neg_hi:[0,1]
    v_pk_add_f32 v[132:133], v[132:133], v[142:143] op_sel_hi:[1,0] neg_lo:[0,1] neg_hi:[0,1]
    v_pk_add_f32 v[134:135], v[134:135], v[142:143] op_sel_hi:[1,0] neg_lo:[0,1] neg_hi:[0,1]
    v_pk_add_f32 v[136:137], v[136:137], v[142:143] op_sel_hi:[1,0] neg_lo:[0,1] neg_hi:[0,1]
    v_pk_add_f32 v[138:139], v[138:139], v[142:143] op_sel_hi:[1,0] neg_lo:[0,1] neg_hi:[0,1]
    v_pk_mul_f32 v[140:141], v[120:121], v[120:121]
    v_pk_fma_f32 v[140:141], v[122:123], v[122:123], v[140:141]
    v_pk_fma_f32 v[140:141], v[124:125], v[124:125], v[140:141]
    v_pk_fma_f32 v[140:141], v[126:127], v[126:127], v[140:141]
    v_pk_fma_f32 v[140:141], v[128:129], v[128:129], v[140:141]
    v_pk_fma_f32 v[140:141], v[130:131], v[130:131], v[140:141]
    v_pk_fma_f32 v[140:141], v[132:133], v[132:133], v[140:141]
    v_pk_fma_f32 v[140:141], v[134:135], v[134:135], v[140:141]
    v_pk_fma_f32 v[140:141], v[136:137], v[136:137], v[140:141]
    v_pk_fma_f32 v[140:141], v[138:139], v[138:139], v[140:141]
    v_add_f32 v140, v140, v141
    s_nop 1
    v_add_f32_dpp v140, v140, v140 quad_perm:[1,0,3,2] row_mask:0xf bank_mask:0xf
    s_nop 1
    v_add_f32_dpp v140, v140, v140 quad_perm:[2,3,0,1] row_mask:0xf bank_mask:0xf
    s_nop 1
    v_add_f32_dpp v140, v140, v140 row_half_mirror row_mask:0xf bank_mask:0xf
    s_nop 1
    v_add_f32_dpp v140, v140, v140 row_mirror row_mask:0xf bank_mask:0xf
    v_mov_b32 v141, v140
    s_nop 1
    v_permlane16_swap_b32 v140, v141
    v_add_f32 v140, v140, v141
    v_mul_f32 v140, s74, v140
    v_cvt_pk_bf16_f32 v141, v140, v140
    v_lshlrev_b32 v141, 16, v141
    v_add_f32 v141, s75, v141
    v_cvt_pk_bf16_f32 v141, v141, v141
    v_lshlrev_b32 v141, 16, v141
    v_sqrt_f32 v141, v141
    s_nop 0
    v_cvt_pk_bf16_f32 v141, v141, v141
    v_lshlrev_b32 v141, 16, v141
    v_rcp_f32 v144, v141
    s_nop 0
    v_pk_mul_f32 v[150:151], v[120:121], v[144:145] op_sel_hi:[1,0]
    v_mul_f32_e64 v140, v140, v144
    v_cvt_pk_bf16_f32 v110, v150, v151
    v_pk_mul_f32 v[150:151], v[122:123], v[144:145] op_sel_hi:[1,0]
    v_mul_f32_e64 v140, v140, v144
    v_cvt_pk_bf16_f32 v111, v150, v151
    v_pk_mul_f32 v[150:151], v[124:125], v[144:145] op_sel_hi:[1,0]
    v_cvt_pk_bf16_f32 v141, v140, v140
    v_lshlrev_b32_e64 v141, 16, v141
    v_cvt_pk_bf16_f32 v112, v150, v151
    v_pk_mul_f32 v[150:151], v[126:127], v[144:145] op_sel_hi:[1,0]
    v_add_f32_e64 v141, s75, v141
    v_cvt_pk_bf16_f32 v113, v150, v151
    v_pk_mul_f32 v[150:151], v[128:129], v[144:145] op_sel_hi:[1,0]
    v_cvt_pk_bf16_f32 v141, v141, v141
    v_lshlrev_b32_e64 v141, 16, v141
    v_cvt_pk_bf16_f32 v114, v150, v151
    v_pk_mul_f32 v[150:151], v[130:131], v[144:145] op_sel_hi:[1,0]
    v_sqrt_f32_e64 v141, v141
    v_cvt_pk_bf16_f32 v115, v150, v151
    v_pk_mul_f32 v[150:151], v[132:133], v[144:145] op_sel_hi:[1,0]
    v_cvt_pk_bf16_f32 v146, v141, v147
    v_cvt_pk_bf16_f32 v116, v150, v151
    v_pk_mul_f32 v[150:151], v[134:135], v[144:145] op_sel_hi:[1,0]
    v_cndmask_b32 v146, 0, v146, vcc
    v_cvt_pk_bf16_f32 v117, v150, v151
    s_nop 0
    v_pk_mul_f32 v[150:151], v[136:137], v[144:145] op_sel_hi:[1,0]
    v_cvt_pk_bf16_f32 v118, v150, v151
    v_pk_mul_f32 v[150:151], v[138:139], v[144:145] op_sel_hi:[1,0]
    v_cvt_pk_bf16_f32 v119, v150, v151
    ds_write_b64 v204, v[110:111] offset:0
    ds_write_b64 v204, v[112:113] offset:256
    ds_write_b64 v204, v[114:115] offset:512
    ds_write_b64 v204, v[116:117] offset:768
    ds_write_b64 v204, v[118:119] offset:1024
    s_mov_b64 exec, s[76:77]
    ds_write_b64 v204, v[146:147] offset:1280
    s_mov_b64 exec, 1
    ds_write_b32 v205, v6
    s_mov_b64 exec, -1
    s_cmp_eq_u32 s3, 3
    s_cbranch_scc1 L_w3
    s_mov_b32 s72, 0x3fb8aa3b
    s_mov_b32 s73, 0x32a57060
    s_mov_b32 s76, 0x3f317218
    s_waitcnt vmcnt(22)
    v_mul_f32_e64 v182, s72, v28
    v_fma_f32 v183, v28, s72, -v182
    v_fma_f32 v183, v28, s73, v183
    v_exp_f32 v182, v182
    v_mul_f32_e64 v183, s76, v183
    v_cmp_eq_u32 vcc, 0, v0
    v_fma_f32 v182, v182, v183, v182
    v_cvt_pk_bf16_f32 v30, v182, v182
    v_lshlrev_b32_e64 v30, 16, v30
    s_waitcnt vmcnt(21)
    v_cndmask_b32 v29, 0, v29, vcc
    v_mul_f32 v31, s72, v30
    s_mov_b32 s74, 0x3e22f983
    s_mov_b32 s75, 0x31dc9c88
    s_mov_b32 s77, 0x43800000
    s_mov_b32 s78, 0x41000000
    s_mul_i32 m0, s3, 8704
    s_waitcnt vmcnt(20)
    v_mul_f32 v182, v10, v31
    s_waitcnt vmcnt(19)
    v_mul_f32 v183, v11, v30
    v_mul_f32_e64 v184, s74, v183
    v_fma_f32 v185, v183, s74, -v184
    v_fma_f32 v185, v183, s75, v185
    v_mul_f32 v186, s78, v182
    v_mul_f32 v187, s78, v184
    v_mul_f32 v188, s77, v182
    v_mul_f32 v189, s77, v184
    v_exp_f32 v186, v186
    v_fract_f32 v187, v187
    v_exp_f32 v188, v188
    v_fract_f32 v189, v189
    v_exp_f32 v190, v182
    v_fract_f32 v191, v184
    v_fma_f32 v187, v185, s78, v187
    v_fma_f32 v189, v185, s77, v189
    v_add_f32 v191, v185, v191
    v_cos_f32 v178, v187
    v_sin_f32 v179, v187
    v_cos_f32 v180, v189
    v_sin_f32 v181, v189
    v_cos_f32 v176, v191
    v_sin_f32 v177, v191
    s_waitcnt vmcnt(15)
    v_pk_mul_f32 v[192:193], v[14:15], v[12:13] op_sel:[0,0] op_sel_hi:[1,0]
    v_pk_fma_f32 v[192:193], v[14:15], v[12:13], v[192:193] op_sel:[1,1,0] op_sel_hi:[0,1,1] neg_lo:[0,1,0]
    v_pk_mul_f32 v[178:179], v[178:179], v[186:187] op_sel_hi:[1,0]
    v_pk_mul_f32 v[180:181], v[180:181], v[188:189] op_sel_hi:[1,0]
    v_pk_mul_f32 v[176:177], v[176:177], v[190:191] op_sel_hi:[1,0]
    v_pk_mul_f32 v[194:195], v[192:193], v[30:31] op_sel_hi:[1,0]
    v_pk_mul_f32 v[116:117], v[178:179], v[178:179] op_sel:[0,0] op_sel_hi:[1,0]
    v_pk_fma_f32 v[116:117], v[178:179], v[178:179], v[116:117] op_sel:[1,1,0] op_sel_hi:[0,1,1] neg_lo:[0,1,0]
    v_pk_mul_f32 v[118:119], v[116:117], v[178:179] op_sel:[0,0] op_sel_hi:[1,0]
    v_pk_fma_f32 v[118:119], v[116:117], v[178:179], v[118:119] op_sel:[1,1,0] op_sel_hi:[0,1,1] neg_lo:[0,1,0]
    v_pk_mul_f32 v[120:121], v[118:119], v[178:179] op_sel:[0,0] op_sel_hi:[1,0]
    v_pk_fma_f32 v[120:121], v[118:119], v[178:179], v[120:121] op_sel:[1,1,0] op_sel_hi:[0,1,1] neg_lo:[0,1,0]
    v_pk_mul_f32 v[122:123], v[120:121], v[178:179] op_sel:[0,0] op_sel_hi:[1,0]
    v_pk_fma_f32 v[122:123], v[120:121], v[178:179], v[122:123] op_sel:[1,1,0] op_sel_hi:[0,1,1] neg_lo:[0,1,0]
    v_pk_mul_f32 v[124:125], v[122:123], v[178:179] op_sel:[0,0] op_sel_hi:[1,0]
    v_pk_fma_f32 v[124:125], v[122:123], v[178:179], v[124:125] op_sel:[1,1,0] op_sel_hi:[0,1,1] neg_lo:[0,1,0]
    v_pk_mul_f32 v[126:127], v[124:125], v[178:179] op_sel:[0,0] op_sel_hi:[1,0]
    v_pk_fma_f32 v[126:127], v[124:125], v[178:179], v[126:127] op_sel:[1,1,0] op_sel_hi:[0,1,1] neg_lo:[0,1,0]
    v_pk_mul_f32 v[128:129], v[126:127], v[178:179] op_sel:[0,0] op_sel_hi:[1,0]
    v_pk_fma_f32 v[128:129], v[126:127], v[178:179], v[128:129] op_sel:[1,1,0] op_sel_hi:[0,1,1] neg_lo:[0,1,0]
    v_pk_mul_f32 v[130:131], v[128:129], v[178:179] op_sel:[0,0] op_sel_hi:[1,0]
    v_pk_fma_f32 v[130:131], v[128:129], v[178:179], v[130:131] op_sel:[1,1,0] op_sel_hi:[0,1,1] neg_lo:[0,1,0]
    v_pk_mul_f32 v[132:133], v[130:131], v[178:179] op_sel:[0,0] op_sel_hi:[1,0]
    v_pk_fma_f32 v[132:133], v[130:131], v[178:179], v[132:133] op_sel:[1,1,0] op_sel_hi:[0,1,1] neg_lo:[0,1,0]
    v_pk_mul_f32 v[134:135], v[132:133], v[178:179] op_sel:[0,0] op_sel_hi:[1,0]
    v_pk_fma_f32 v[134:135], v[132:133], v[178:179], v[134:135] op_sel:[1,1,0] op_sel_hi:[0,1,1] neg_lo:[0,1,0]
    v_pk_mul_f32 v[136:137], v[134:135], v[178:179] op_sel:[0,0] op_sel_hi:[1,0]
    v_pk_fma_f32 v[136:137], v[134:135], v[178:179], v[136:137] op_sel:[1,1,0] op_sel_hi:[0,1,1] neg_lo:[0,1,0]
    v_pk_mul_f32 v[138:139], v[136:137], v[178:179] op_sel:[0,0] op_sel_hi:[1,0]
    v_pk_fma_f32 v[138:139], v[136:137], v[178:179], v[138:139] op_sel:[1,1,0] op_sel_hi:[0,1,1] neg_lo:[0,1,0]
    v_pk_mul_f32 v[140:141], v[138:139], v[178:179] op_sel:[0,0] op_sel_hi:[1,0]
    v_pk_fma_f32 v[140:141], v[138:139], v[178:179], v[140:141] op_sel:[1,1,0] op_sel_hi:[0,1,1] neg_lo:[0,1,0]
    v_pk_mul_f32 v[142:143], v[140:141], v[178:179] op_sel:[0,0] op_sel_hi:[1,0]
    v_pk_fma_f32 v[142:143], v[140:141], v[178:179], v[142:143] op_sel:[1,1,0] op_sel_hi:[0,1,1] neg_lo:[0,1,0]
    v_pk_mul_f32 v[144:145], v[142:143], v[178:179] op_sel:[0,0] op_sel_hi:[1,0]
    v_pk_fma_f32 v[144:145], v[142:143], v[178:179], v[144:145] op_sel:[1,1,0] op_sel_hi:[0,1,1] neg_lo:[0,1,0]
    v_pk_mul_f32 v[146:147], v[144:145], v[178:179] op_sel:[0,0] op_sel_hi:[1,0]
    v_pk_fma_f32 v[146:147], v[144:145], v[178:179], v[146:147] op_sel:[1,1,0] op_sel_hi:[0,1,1] neg_lo:[0,1,0]
    v_pk_mul_f32 v[148:149], v[146:147], v[178:179] op_sel:[0,0] op_sel_hi:[1,0]
    v_pk_fma_f32 v[148:149], v[146:147], v[178:179], v[148:149] op_sel:[1,1,0] op_sel_hi:[0,1,1] neg_lo:[0,1,0]
    v_pk_mul_f32 v[150:151], v[148:149], v[178:179] op_sel:[0,0] op_sel_hi:[1,0]
    v_pk_fma_f32 v[150:151], v[148:149], v[178:179], v[150:151] op_sel:[1,1,0] op_sel_hi:[0,1,1] neg_lo:[0,1,0]
    v_pk_mul_f32 v[152:153], v[150:151], v[178:179] op_sel:[0,0] op_sel_hi:[1,0]
    v_pk_fma_f32 v[152:153], v[150:151], v[178:179], v[152:153] op_sel:[1,1,0] op_sel_hi:[0,1,1] neg_lo:[0,1,0]
    v_pk_mul_f32 v[154:155], v[152:153], v[178:179] op_sel:[0,0] op_sel_hi:[1,0]
    v_pk_fma_f32 v[154:155], v[152:153], v[178:179], v[154:155] op_sel:[1,1,0] op_sel_hi:[0,1,1] neg_lo:[0,1,0]
    v_pk_mul_f32 v[156:157], v[154:155], v[178:179] op_sel:[0,0] op_sel_hi:[1,0]
    v_pk_fma_f32 v[156:157], v[154:155], v[178:179], v[156:157] op_sel:[1,1,0] op_sel_hi:[0,1,1] neg_lo:[0,1,0]
    v_pk_mul_f32 v[158:159], v[156:157], v[178:179] op_sel:[0,0] op_sel_hi:[1,0]
    v_pk_fma_f32 v[158:159], v[156:157], v[178:179], v[158:159] op_sel:[1,1,0] op_sel_hi:[0,1,1] neg_lo:[0,1,0]
    v_pk_mul_f32 v[160:161], v[158:159], v[178:179] op_sel:[0,0] op_sel_hi:[1,0]
    v_pk_fma_f32 v[160:161], v[158:159], v[178:179], v[160:161] op_sel:[1,1,0] op_sel_hi:[0,1,1] neg_lo:[0,1,0]
    v_pk_mul_f32 v[162:163], v[160:161], v[178:179] op_sel:[0,0] op_sel_hi:[1,0]
    v_pk_fma_f32 v[162:163], v[160:161], v[178:179], v[162:163] op_sel:[1,1,0] op_sel_hi:[0,1,1] neg_lo:[0,1,0]
    v_pk_mul_f32 v[164:165], v[162:163], v[178:179] op_sel:[0,0] op_sel_hi:[1,0]
    v_pk_fma_f32 v[164:165], v[162:163], v[178:179], v[164:165] op_sel:[1,1,0] op_sel_hi:[0,1,1] neg_lo:[0,1,0]
    v_pk_mul_f32 v[166:167], v[164:165], v[178:179] op_sel:[0,0] op_sel_hi:[1,0]
    v_pk_fma_f32 v[166:167], v[164:165], v[178:179], v[166:167] op_sel:[1,1,0] op_sel_hi:[0,1,1] neg_lo:[0,1,0]
    v_pk_mul_f32 v[168:169], v[166:167], v[178:179] op_sel:[0,0] op_sel_hi:[1,0]
    v_pk_fma_f32 v[168:169], v[166:167], v[178:179], v[168:169] op_sel:[1,1,0] op_sel_hi:[0,1,1] neg_lo:[0,1,0]
    v_pk_mul_f32 v[170:171], v[168:169], v[178:179] op_sel:[0,0] op_sel_hi:[1,0]
    v_pk_fma_f32 v[170:171], v[168:169], v[178:179], v[170:171] op_sel:[1,1,0] op_sel_hi:[0,1,1] neg_lo:[0,1,0]
    v_pk_mul_f32 v[172:173], v[170:171], v[178:179] op_sel:[0,0] op_sel_hi:[1,0]
    v_pk_fma_f32 v[172:173], v[170:171], v[178:179], v[172:173] op_sel:[1,1,0] op_sel_hi:[0,1,1] neg_lo:[0,1,0]
    v_pk_mul_f32 v[174:175], v[172:173], v[178:179] op_sel:[0,0] op_sel_hi:[1,0]
    v_pk_fma_f32 v[174:175], v[172:173], v[178:179], v[174:175] op_sel:[1,1,0] op_sel_hi:[0,1,1] neg_lo:[0,1,0]
    v_mov_b32 v112, 0x3f80
    v_cvt_pk_bf16_f32 v114, v178, v179
    v_cvt_pk_bf16_f32 v116, v116, v117
    v_cvt_pk_bf16_f32 v118, v118, v119
    v_cvt_pk_bf16_f32 v120, v120, v121
    v_cvt_pk_bf16_f32 v122, v122, v123
    v_cvt_pk_bf16_f32 v124, v124, v125
    v_cvt_pk_bf16_f32 v126, v126, v127
    v_cvt_pk_bf16_f32 v128, v128, v129
    v_cvt_pk_bf16_f32 v130, v130, v131
    v_cvt_pk_bf16_f32 v132, v132, v133
    v_cvt_pk_bf16_f32 v134, v134, v135
    v_cvt_pk_bf16_f32 v136, v136, v137
    v_cvt_pk_bf16_f32 v138, v138, v139
    v_cvt_pk_bf16_f32 v140, v140, v141
    v_cvt_pk_bf16_f32 v142, v142, v143
    v_cvt_pk_bf16_f32 v144, v144, v145
    v_cvt_pk_bf16_f32 v146, v146, v147
    v_cvt_pk_bf16_f32 v148, v148, v149
    v_cvt_pk_bf16_f32 v150, v150, v151
    v_cvt_pk_bf16_f32 v152, v152, v153
    v_cvt_pk_bf16_f32 v154, v154, v155
    v_cvt_pk_bf16_f32 v156, v156, v157
    v_cvt_pk_bf16_f32 v158, v158, v159
    v_cvt_pk_bf16_f32 v160, v160, v161
    v_cvt_pk_bf16_f32 v162, v162, v163
    v_cvt_pk_bf16_f32 v164, v164, v165
    v_cvt_pk_bf16_f32 v166, v166, v167
    v_cvt_pk_bf16_f32 v168, v168, v169
    v_cvt_pk_bf16_f32 v170, v170, v171
    v_cvt_pk_bf16_f32 v172, v172, v173
    v_cvt_pk_bf16_f32 v174, v174, v175
    ds_write_addtid_b32 v112 offset:0
    ds_write_addtid_b32 v114 offset:272
    ds_write_addtid_b32 v116 offset:544
    ds_write_addtid_b32 v118 offset:816
    ds_write_addtid_b32 v120 offset:1088
    ds_write_addtid_b32 v122 offset:1360
    ds_write_addtid_b32 v124 offset:1632
    ds_write_addtid_b32 v126 offset:1904
    ds_write_addtid_b32 v128 offset:2176
    ds_write_addtid_b32 v130 offset:2448
    ds_write_addtid_b32 v132 offset:2720
    ds_write_addtid_b32 v134 offset:2992
    ds_write_addtid_b32 v136 offset:3264
    ds_write_addtid_b32 v138 offset:3536
    ds_write_addtid_b32 v140 offset:3808
    ds_write_addtid_b32 v142 offset:4080
    ds_write_addtid_b32 v144 offset:4352
    ds_write_addtid_b32 v146 offset:4624
    ds_write_addtid_b32 v148 offset:4896
    ds_write_addtid_b32 v150 offset:5168
    ds_write_addtid_b32 v152 offset:5440
    ds_write_addtid_b32 v154 offset:5712
    ds_write_addtid_b32 v156 offset:5984
    ds_write_addtid_b32 v158 offset:6256
    ds_write_addtid_b32 v160 offset:6528
    ds_write_addtid_b32 v162 offset:6800
    ds_write_addtid_b32 v164 offset:7072
    ds_write_addtid_b32 v166 offset:7344
    ds_write_addtid_b32 v168 offset:7616
    ds_write_addtid_b32 v170 offset:7888
    ds_write_addtid_b32 v172 offset:8160
    ds_write_addtid_b32 v174 offset:8432
    v_pk_mul_f32 v[114:115], v[194:195], v[176:177] op_sel:[0,0] op_sel_hi:[1,0]
    v_pk_fma_f32 v[114:115], v[194:195], v[176:177], v[114:115] op_sel:[1,1,0] op_sel_hi:[0,1,1] neg_lo:[0,1,0]
    v_pk_mul_f32 v[116:117], v[114:115], v[176:177] op_sel:[0,0] op_sel_hi:[1,0]
    v_pk_fma_f32 v[116:117], v[114:115], v[176:177], v[116:117] op_sel:[1,1,0] op_sel_hi:[0,1,1] neg_lo:[0,1,0]
    v_pk_mul_f32 v[118:119], v[116:117], v[176:177] op_sel:[0,0] op_sel_hi:[1,0]
    v_pk_fma_f32 v[118:119], v[116:117], v[176:177], v[118:119] op_sel:[1,1,0] op_sel_hi:[0,1,1] neg_lo:[0,1,0]
    v_pk_mul_f32 v[120:121], v[118:119], v[176:177] op_sel:[0,0] op_sel_hi:[1,0]
    v_pk_fma_f32 v[120:121], v[118:119], v[176:177], v[120:121] op_sel:[1,1,0] op_sel_hi:[0,1,1] neg_lo:[0,1,0]
    ds_read_b128 v[48:51], v210 offset:0
    ds_read_b128 v[52:55], v210 offset:32
    ds_read_b128 v[56:59], v210 offset:64
    ds_read_b128 v[60:63], v210 offset:96
    ds_read_b128 v[64:67], v210 offset:128
    ds_read_b128 v[68:71], v210 offset:160
    ds_read_b128 v[72:75], v210 offset:192
    ds_read_b128 v[76:79], v210 offset:224
    v_pk_mul_f32 v[122:123], v[120:121], v[176:177] op_sel:[0,0] op_sel_hi:[1,0]
    v_pk_fma_f32 v[122:123], v[120:121], v[176:177], v[122:123] op_sel:[1,1,0] op_sel_hi:[0,1,1] neg_lo:[0,1,0]
    v_pk_mul_f32 v[124:125], v[122:123], v[176:177] op_sel:[0,0] op_sel_hi:[1,0]
    v_pk_fma_f32 v[124:125], v[122:123], v[176:177], v[124:125] op_sel:[1,1,0] op_sel_hi:[0,1,1] neg_lo:[0,1,0]
    v_pk_mul_f32 v[126:127], v[124:125], v[176:177] op_sel:[0,0] op_sel_hi:[1,0]
    v_pk_fma_f32 v[126:127], v[124:125], v[176:177], v[126:127] op_sel:[1,1,0] op_sel_hi:[0,1,1] neg_lo:[0,1,0]
    v_pk_mul_f32 v[128:129], v[194:195], v[180:181] op_sel:[0,0] op_sel_hi:[1,0]
    v_pk_fma_f32 v[128:129], v[194:195], v[180:181], v[128:129] op_sel:[1,1,0] op_sel_hi:[0,1,1] neg_lo:[0,1,0]
    v_pk_mul_f32 v[130:131], v[116:117], v[180:181] op_sel:[0,0] op_sel_hi:[1,0]
    v_pk_fma_f32 v[130:131], v[116:117], v[180:181], v[130:131] op_sel:[1,1,0] op_sel_hi:[0,1,1] neg_lo:[0,1,0]
    v_pk_mul_f32 v[132:133], v[120:121], v[180:181] op_sel:[0,0] op_sel_hi:[1,0]
    v_pk_fma_f32 v[132:133], v[120:121], v[180:181], v[132:133] op_sel:[1,1,0] op_sel_hi:[0,1,1] neg_lo:[0,1,0]
    v_pk_mul_f32 v[134:135], v[124:125], v[180:181] op_sel:[0,0] op_sel_hi:[1,0]
    v_pk_fma_f32 v[134:135], v[124:125], v[180:181], v[134:135] op_sel:[1,1,0] op_sel_hi:[0,1,1] neg_lo:[0,1,0]
    v_pk_mul_f32 v[136:137], v[128:129], v[180:181] op_sel:[0,0] op_sel_hi:[1,0]
    v_pk_fma_f32 v[136:137], v[128:129], v[180:181], v[136:137] op_sel:[1,1,0] op_sel_hi:[0,1,1] neg_lo:[0,1,0]
    v_pk_mul_f32 v[138:139], v[132:133], v[180:181] op_sel:[0,0] op_sel_hi:[1,0]
    v_pk_fma_f32 v[138:139], v[132:133], v[180:181], v[138:139] op_sel:[1,1,0] op_sel_hi:[0,1,1] neg_lo:[0,1,0]
    v_pk_mul_f32 v[140:141], v[136:137], v[180:181] op_sel:[0,0] op_sel_hi:[1,0]
    v_pk_fma_f32 v[140:141], v[136:137], v[180:181], v[140:141] op_sel:[1,1,0] op_sel_hi:[0,1,1] neg_lo:[0,1,0]
    v_pk_mul_f32 v[142:143], v[138:139], v[180:181] op_sel:[0,0] op_sel_hi:[1,0]
    v_pk_fma_f32 v[142:143], v[138:139], v[180:181], v[142:143] op_sel:[1,1,0] op_sel_hi:[0,1,1] neg_lo:[0,1,0]
    v_pk_mul_f32 v[144:145], v[140:141], v[180:181] op_sel:[0,0] op_sel_hi:[1,0]
    v_pk_fma_f32 v[144:145], v[140:141], v[180:181], v[144:145] op_sel:[1,1,0] op_sel_hi:[0,1,1] neg_lo:[0,1,0]
    v_pk_mul_f32 v[146:147], v[144:145], v[180:181] op_sel:[0,0] op_sel_hi:[1,0]
    v_pk_fma_f32 v[146:147], v[144:145], v[180:181], v[146:147] op_sel:[1,1,0] op_sel_hi:[0,1,1] neg_lo:[0,1,0]
    v_pk_mul_f32 v[148:149], v[146:147], v[180:181] op_sel:[0,0] op_sel_hi:[1,0]
    v_pk_fma_f32 v[148:149], v[146:147], v[180:181], v[148:149] op_sel:[1,1,0] op_sel_hi:[0,1,1] neg_lo:[0,1,0]
    v_pk_mul_f32 v[150:151], v[148:149], v[180:181] op_sel:[0,0] op_sel_hi:[1,0]
    v_pk_fma_f32 v[150:151], v[148:149], v[180:181], v[150:151] op_sel:[1,1,0] op_sel_hi:[0,1,1] neg_lo:[0,1,0]
    v_pk_mul_f32 v[152:153], v[150:151], v[180:181] op_sel:[0,0] op_sel_hi:[1,0]
    v_pk_fma_f32 v[152:153], v[150:151], v[180:181], v[152:153] op_sel:[1,1,0] op_sel_hi:[0,1,1] neg_lo:[0,1,0]
    v_cvt_pk_bf16_f32 v194, v194, -v195
    v_cvt_pk_bf16_f32 v114, v114, -v115
    v_cvt_pk_bf16_f32 v116, v116, -v117
    v_cvt_pk_bf16_f32 v118, v118, -v119
    v_cvt_pk_bf16_f32 v120, v120, -v121
    v_cvt_pk_bf16_f32 v122, v122, -v123
    v_cvt_pk_bf16_f32 v124, v124, -v125
    v_cvt_pk_bf16_f32 v126, v126, -v127
    v_cvt_pk_bf16_f32 v128, v128, -v129
    v_cvt_pk_bf16_f32 v130, v130, -v131
    v_cvt_pk_bf16_f32 v132, v132, -v133
    v_cvt_pk_bf16_f32 v134, v134, -v135
    v_cvt_pk_bf16_f32 v136, v136, -v137
    v_cvt_pk_bf16_f32 v138, v138, -v139
    v_cvt_pk_bf16_f32 v140, v140, -v141
    v_cvt_pk_bf16_f32 v142, v142, -v143
    v_cvt_pk_bf16_f32 v144, v144, -v145
    v_cvt_pk_bf16_f32 v146, v146, -v147
    v_cvt_pk_bf16_f32 v148, v148, -v149
    v_cvt_pk_bf16_f32 v150, v150, -v151
    v_cvt_pk_bf16_f32 v152, v152, -v153
    ds_write_addtid_b32 v194 offset:0
    ds_write_addtid_b32 v114 offset:272
    ds_write_addtid_b32 v116 offset:544
    ds_write_addtid_b32 v118 offset:816
    ds_write_addtid_b32 v120 offset:1088
    ds_write_addtid_b32 v122 offset:1360
    ds_write_addtid_b32 v124 offset:1632
    ds_write_addtid_b32 v126 offset:1904
    ds_write_addtid_b32 v128 offset:2176
    ds_write_addtid_b32 v130 offset:2448
    ds_write_addtid_b32 v132 offset:2720
    ds_write_addtid_b32 v134 offset:2992
    ds_write_addtid_b32 v136 offset:3264
    ds_write_addtid_b32 v138 offset:3536
    ds_write_addtid_b32 v140 offset:3808
    ds_write_addtid_b32 v142 offset:4080
    ds_write_addtid_b32 v144 offset:4352
    ds_write_addtid_b32 v146 offset:4624
    ds_write_addtid_b32 v148 offset:4896
    ds_write_addtid_b32 v150 offset:5168
    ds_write_addtid_b32 v152 offset:6256
    s_waitcnt vmcnt(14)
    v_mul_f32_e64 v182, v16, v31
    s_waitcnt vmcnt(13)
    v_mul_f32 v183, v17, v30
    v_mul_f32 v184, s74, v183
    v_fma_f32 v185, v183, s74, -v184
    v_fma_f32 v185, v183, s75, v185
    v_mul_f32_e64 v186, s78, v182
    ds_read_b128 v[80:83], v210 offset:0
    ds_read_b128 v[84:87], v210 offset:32
    ds_read_b128 v[88:91], v210 offset:64
    ds_read_b128 v[92:95], v210 offset:96
    ds_read_b128 v[96:99], v210 offset:128
    ds_read_b128 v[100:103], v210 offset:160
    ds_read_b128 v[104:107], v210 offset:192
    ds_read_b128 v[108:111], v210 offset:224
    v_mul_f32_e64 v187, s78, v184
    v_mul_f32 v188, s77, v182
    v_mul_f32 v189, s77, v184
    v_exp_f32 v186, v186
    v_fract_f32 v187, v187
    v_exp_f32 v188, v188
    v_fract_f32 v189, v189
    v_exp_f32 v190, v182
    v_fract_f32 v191, v184
    v_fma_f32 v187, v185, s78, v187
    v_fma_f32 v189, v185, s77, v189
    v_add_f32 v191, v185, v191
    v_cos_f32 v178, v187
    v_sin_f32 v179, v187
    v_cos_f32 v180, v189
    v_sin_f32 v181, v189
    v_cos_f32 v176, v191
    v_sin_f32 v177, v191
    s_waitcnt vmcnt(9)
    v_pk_mul_f32 v[192:193], v[20:21], v[18:19] op_sel:[0,0] op_sel_hi:[1,0]
    v_pk_fma_f32 v[192:193], v[20:21], v[18:19], v[192:193] op_sel:[1,1,0] op_sel_hi:[0,1,1] neg_lo:[0,1,0]
    v_pk_mul_f32 v[178:179], v[178:179], v[186:187] op_sel_hi:[1,0]
    v_pk_mul_f32 v[180:181], v[180:181], v[188:189] op_sel_hi:[1,0]
    v_pk_mul_f32 v[176:177], v[176:177], v[190:191] op_sel_hi:[1,0]
    v_pk_mul_f32 v[194:195], v[192:193], v[30:31] op_sel_hi:[1,0]
    v_pk_mul_f32 v[116:117], v[178:179], v[178:179] op_sel:[0,0] op_sel_hi:[1,0]
    v_pk_fma_f32 v[116:117], v[178:179], v[178:179], v[116:117] op_sel:[1,1,0] op_sel_hi:[0,1,1] neg_lo:[0,1,0]
    v_pk_mul_f32 v[118:119], v[116:117], v[178:179] op_sel:[0,0] op_sel_hi:[1,0]
    v_pk_fma_f32 v[118:119], v[116:117], v[178:179], v[118:119] op_sel:[1,1,0] op_sel_hi:[0,1,1] neg_lo:[0,1,0]
    v_pk_mul_f32 v[120:121], v[118:119], v[178:179] op_sel:[0,0] op_sel_hi:[1,0]
    v_pk_fma_f32 v[120:121], v[118:119], v[178:179], v[120:121] op_sel:[1,1,0] op_sel_hi:[0,1,1] neg_lo:[0,1,0]
    v_pk_mul_f32 v[122:123], v[120:121], v[178:179] op_sel:[0,0] op_sel_hi:[1,0]
    v_pk_fma_f32 v[122:123], v[120:121], v[178:179], v[122:123] op_sel:[1,1,0] op_sel_hi:[0,1,1] neg_lo:[0,1,0]
    v_pk_mul_f32 v[124:125], v[122:123], v[178:179] op_sel:[0,0] op_sel_hi:[1,0]
    v_pk_fma_f32 v[124:125], v[122:123], v[178:179], v[124:125] op_sel:[1,1,0] op_sel_hi:[0,1,1] neg_lo:[0,1,0]
    v_pk_mul_f32 v[126:127], v[124:125], v[178:179] op_sel:[0,0] op_sel_hi:[1,0]
    v_pk_fma_f32 v[126:127], v[124:125], v[178:179], v[126:127] op_sel:[1,1,0] op_sel_hi:[0,1,1] neg_lo:[0,1,0]
    v_pk_mul_f32 v[128:129], v[126:127], v[178:179] op_sel:[0,0] op_sel_hi:[1,0]
    v_pk_fma_f32 v[128:129], v[126:127], v[178:179], v[128:129] op_sel:[1,1,0] op_sel_hi:[0,1,1] neg_lo:[0,1,0]
    v_pk_mul_f32 v[130:131], v[128:129], v[178:179] op_sel:[0,0] op_sel_hi:[1,0]
    v_pk_fma_f32 v[130:131], v[128:129], v[178:179], v[130:131] op_sel:[1,1,0] op_sel_hi:[0,1,1] neg_lo:[0,1,0]
    v_pk_mul_f32 v[132:133], v[130:131], v[178:179] op_sel:[0,0] op_sel_hi:[1,0]
    v_pk_fma_f32 v[132:133], v[130:131], v[178:179], v[132:133] op_sel:[1,1,0] op_sel_hi:[0,1,1] neg_lo:[0,1,0]
    v_pk_mul_f32 v[134:135], v[132:133], v[178:179] op_sel:[0,0] op_sel_hi:[1,0]
    v_pk_fma_f32 v[134:135], v[132:133], v[178:179], v[134:135] op_sel:[1,1,0] op_sel_hi:[0,1,1] neg_lo:[0,1,0]
    v_pk_mul_f32 v[136:137], v[134:135], v[178:179] op_sel:[0,0] op_sel_hi:[1,0]
    v_pk_fma_f32 v[136:137], v[134:135], v[178:179], v[136:137] op_sel:[1,1,0] op_sel_hi:[0,1,1] neg_lo:[0,1,0]
    v_pk_mul_f32 v[138:139], v[136:137], v[178:179] op_sel:[0,0] op_sel_hi:[1,0]
    v_pk_fma_f32 v[138:139], v[136:137], v[178:179], v[138:139] op_sel:[1,1,0] op_sel_hi:[0,1,1] neg_lo:[0,1,0]
    v_pk_mul_f32 v[140:141], v[138:139], v[178:179] op_sel:[0,0] op_sel_hi:[1,0]
    v_pk_fma_f32 v[140:141], v[138:139], v[178:179], v[140:141] op_sel:[1,1,0] op_sel_hi:[0,1,1] neg_lo:[0,1,0]
    v_pk_mul_f32 v[142:143], v[140:141], v[178:179] op_sel:[0,0] op_sel_hi:[1,0]
    v_pk_fma_f32 v[142:143], v[140:141], v[178:179], v[142:143] op_sel:[1,1,0] op_sel_hi:[0,1,1] neg_lo:[0,1,0]
    v_pk_mul_f32 v[144:145], v[142:143], v[178:179] op_sel:[0,0] op_sel_hi:[1,0]
    v_pk_fma_f32 v[144:145], v[142:143], v[178:179], v[144:145] op_sel:[1,1,0] op_sel_hi:[0,1,1] neg_lo:[0,1,0]
    v_pk_mul_f32 v[146:147], v[144:145], v[178:179] op_sel:[0,0] op_sel_hi:[1,0]
    v_pk_fma_f32 v[146:147], v[144:145], v[178:179], v[146:147] op_sel:[1,1,0] op_sel_hi:[0,1,1] neg_lo:[0,1,0]
    v_pk_mul_f32 v[148:149], v[146:147], v[178:179] op_sel:[0,0] op_sel_hi:[1,0]
    v_pk_fma_f32 v[148:149], v[146:147], v[178:179], v[148:149] op_sel:[1,1,0] op_sel_hi:[0,1,1] neg_lo:[0,1,0]
    v_pk_mul_f32 v[150:151], v[148:149], v[178:179] op_sel:[0,0] op_sel_hi:[1,0]
    v_pk_fma_f32 v[150:151], v[148:149], v[178:179], v[150:151] op_sel:[1,1,0] op_sel_hi:[0,1,1] neg_lo:[0,1,0]
    v_pk_mul_f32 v[152:153], v[150:151], v[178:179] op_sel:[0,0] op_sel_hi:[1,0]
    v_pk_fma_f32 v[152:153], v[150:151], v[178:179], v[152:153] op_sel:[1,1,0] op_sel_hi:[0,1,1] neg_lo:[0,1,0]
    v_pk_mul_f32 v[154:155], v[152:153], v[178:179] op_sel:[0,0] op_sel_hi:[1,0]
    v_pk_fma_f32 v[154:155], v[152:153], v[178:179], v[154:155] op_sel:[1,1,0] op_sel_hi:[0,1,1] neg_lo:[0,1,0]
    v_pk_mul_f32 v[156:157], v[154:155], v[178:179] op_sel:[0,0] op_sel_hi:[1,0]
    v_pk_fma_f32 v[156:157], v[154:155], v[178:179], v[156:157] op_sel:[1,1,0] op_sel_hi:[0,1,1] neg_lo:[0,1,0]
    v_pk_mul_f32 v[158:159], v[156:157], v[178:179] op_sel:[0,0] op_sel_hi:[1,0]
    v_pk_fma_f32 v[158:159], v[156:157], v[178:179], v[158:159] op_sel:[1,1,0] op_sel_hi:[0,1,1] neg_lo:[0,1,0]
    v_pk_mul_f32 v[160:161], v[158:159], v[178:179] op_sel:[0,0] op_sel_hi:[1,0]
    v_pk_fma_f32 v[160:161], v[158:159], v[178:179], v[160:161] op_sel:[1,1,0] op_sel_hi:[0,1,1] neg_lo:[0,1,0]
    v_pk_mul_f32 v[162:163], v[160:161], v[178:179] op_sel:[0,0] op_sel_hi:[1,0]
    v_pk_fma_f32 v[162:163], v[160:161], v[178:179], v[162:163] op_sel:[1,1,0] op_sel_hi:[0,1,1] neg_lo:[0,1,0]
    v_pk_mul_f32 v[164:165], v[162:163], v[178:179] op_sel:[0,0] op_sel_hi:[1,0]
    v_pk_fma_f32 v[164:165], v[162:163], v[178:179], v[164:165] op_sel:[1,1,0] op_sel_hi:[0,1,1] neg_lo:[0,1,0]
    v_pk_mul_f32 v[166:167], v[164:165], v[178:179] op_sel:[0,0] op_sel_hi:[1,0]
    v_pk_fma_f32 v[166:167], v[164:165], v[178:179], v[166:167] op_sel:[1,1,0] op_sel_hi:[0,1,1] neg_lo:[0,1,0]
    v_pk_mul_f32 v[168:169], v[166:167], v[178:179] op_sel:[0,0] op_sel_hi:[1,0]
    v_pk_fma_f32 v[168:169], v[166:167], v[178:179], v[168:169] op_sel:[1,1,0] op_sel_hi:[0,1,1] neg_lo:[0,1,0]
    v_pk_mul_f32 v[170:171], v[168:169], v[178:179] op_sel:[0,0] op_sel_hi:[1,0]
    v_pk_fma_f32 v[170:171], v[168:169], v[178:179], v[170:171] op_sel:[1,1,0] op_sel_hi:[0,1,1] neg_lo:[0,1,0]
    v_pk_mul_f32 v[172:173], v[170:171], v[178:179] op_sel:[0,0] op_sel_hi:[1,0]
    v_pk_fma_f32 v[172:173], v[170:171], v[178:179], v[172:173] op_sel:[1,1,0] op_sel_hi:[0,1,1] neg_lo:[0,1,0]
    v_pk_mul_f32 v[174:175], v[172:173], v[178:179] op_sel:[0,0] op_sel_hi:[1,0]
    v_pk_fma_f32 v[174:175], v[172:173], v[178:179], v[174:175] op_sel:[1,1,0] op_sel_hi:[0,1,1] neg_lo:[0,1,0]
    v_mov_b32 v112, 0x3f80
    v_cvt_pk_bf16_f32 v114, v178, v179
    v_cvt_pk_bf16_f32 v116, v116, v117
    v_cvt_pk_bf16_f32 v118, v118, v119
    v_cvt_pk_bf16_f32 v120, v120, v121
    v_cvt_pk_bf16_f32 v122, v122, v123
    v_cvt_pk_bf16_f32 v124, v124, v125
    v_cvt_pk_bf16_f32 v126, v126, v127
    v_cvt_pk_bf16_f32 v128, v128, v129
    v_cvt_pk_bf16_f32 v130, v130, v131
    v_cvt_pk_bf16_f32 v132, v132, v133
    v_cvt_pk_bf16_f32 v134, v134, v135
    v_cvt_pk_bf16_f32 v136, v136, v137
    v_cvt_pk_bf16_f32 v138, v138, v139
    v_cvt_pk_bf16_f32 v140, v140, v141
    v_cvt_pk_bf16_f32 v142, v142, v143
    v_cvt_pk_bf16_f32 v144, v144, v145
    v_cvt_pk_bf16_f32 v146, v146, v147
    s_waitcnt lgkmcnt(7)
    v_mfma_f32_32x32x16_bf16 v[32:47], v[80:83], v[48:51], 0
    s_nop 0
    ds_write_addtid_b32 v112 offset:0
    ds_write_addtid_b32 v114 offset:272
    ds_write_addtid_b32 v116 offset:544
    ds_write_addtid_b32 v118 offset:816
    v_cvt_pk_bf16_f32 v148, v148, v149
    v_cvt_pk_bf16_f32 v150, v150, v151
    s_waitcnt lgkmcnt(10)
    v_mfma_f32_32x32x16_bf16 v[32:47], v[84:87], v[52:55], v[32:47]
    s_nop 0
    ds_write_addtid_b32 v120 offset:1088
    ds_write_addtid_b32 v122 offset:1360
    ds_write_addtid_b32 v124 offset:1632
    ds_write_addtid_b32 v126 offset:1904
    v_cvt_pk_bf16_f32 v152, v152, v153
    v_cvt_pk_bf16_f32 v154, v154, v155
    s_waitcnt lgkmcnt(13)
    v_mfma_f32_32x32x16_bf16 v[32:47], v[88:91], v[56:59], v[32:47]
    s_nop 0
    ds_write_addtid_b32 v128 offset:2176
    ds_write_addtid_b32 v130 offset:2448
    ds_write_addtid_b32 v132 offset:2720
    ds_write_addtid_b32 v134 offset:2992
    v_cvt_pk_bf16_f32 v156, v156, v157
    v_cvt_pk_bf16_f32 v158, v158, v159
    s_waitcnt lgkmcnt(14)
    v_mfma_f32_32x32x16_bf16 v[32:47], v[92:95], v[60:63], v[32:47]
    s_nop 0
    ds_write_addtid_b32 v136 offset:3264
    ds_write_addtid_b32 v138 offset:3536
    ds_write_addtid_b32 v140 offset:3808
    ds_write_addtid_b32 v142 offset:4080
    v_cvt_pk_bf16_f32 v160, v160, v161
    v_cvt_pk_bf16_f32 v162, v162, v163
    v_mfma_f32_32x32x16_bf16 v[32:47], v[96:99], v[64:67], v[32:47]
    ds_write_addtid_b32 v144 offset:4352
    ds_write_addtid_b32 v146 offset:4624
    ds_write_addtid_b32 v148 offset:4896
    ds_write_addtid_b32 v150 offset:5168
    v_cvt_pk_bf16_f32 v164, v164, v165
    v_cvt_pk_bf16_f32 v166, v166, v167
    v_mfma_f32_32x32x16_bf16 v[32:47], v[100:103], v[68:71], v[32:47]
    ds_write_addtid_b32 v152 offset:5440
    ds_write_addtid_b32 v154 offset:5712
    ds_write_addtid_b32 v156 offset:5984
    ds_write_addtid_b32 v158 offset:6256
    v_cvt_pk_bf16_f32 v168, v168, v169
    v_cvt_pk_bf16_f32 v170, v170, v171
    s_waitcnt lgkmcnt(14)
    v_mfma_f32_32x32x16_bf16 v[32:47], v[104:107], v[72:75], v[32:47]
    s_nop 0
    ds_write_addtid_b32 v160 offset:6528
    ds_write_addtid_b32 v162 offset:6800
    ds_write_addtid_b32 v164 offset:7072
    ds_write_addtid_b32 v166 offset:7344
    v_cvt_pk_bf16_f32 v172, v172, v173
    v_cvt_pk_bf16_f32 v174, v174, v175
    v_mfma_f32_32x32x16_bf16 v[32:47], v[108:111], v[76:79], v[32:47]
    ds_write_addtid_b32 v168 offset:7616
    ds_write_addtid_b32 v170 offset:7888
    ds_write_addtid_b32 v172 offset:8160
    ds_write_addtid_b32 v174 offset:8432
    v_pk_mul_f32 v[114:115], v[194:195], v[176:177] op_sel:[0,0] op_sel_hi:[1,0]
    v_pk_fma_f32 v[114:115], v[194:195], v[176:177], v[114:115] op_sel:[1,1,0] op_sel_hi:[0,1,1] neg_lo:[0,1,0]
    v_pk_mul_f32 v[116:117], v[114:115], v[176:177] op_sel:[0,0] op_sel_hi:[1,0]
    v_pk_fma_f32 v[116:117], v[114:115], v[176:177], v[116:117] op_sel:[1,1,0] op_sel_hi:[0,1,1] neg_lo:[0,1,0]
    v_pk_mul_f32 v[118:119], v[116:117], v[176:177] op_sel:[0,0] op_sel_hi:[1,0]
    v_pk_fma_f32 v[118:119], v[116:117], v[176:177], v[118:119] op_sel:[1,1,0] op_sel_hi:[0,1,1] neg_lo:[0,1,0]
    v_pk_mul_f32 v[120:121], v[118:119], v[176:177] op_sel:[0,0] op_sel_hi:[1,0]
    v_pk_fma_f32 v[120:121], v[118:119], v[176:177], v[120:121] op_sel:[1,1,0] op_sel_hi:[0,1,1] neg_lo:[0,1,0]
    ds_read_b128 v[48:51], v210 offset:0
    ds_read_b128 v[52:55], v210 offset:32
    ds_read_b128 v[56:59], v210 offset:64
    ds_read_b128 v[60:63], v210 offset:96
    ds_read_b128 v[64:67], v210 offset:128
    ds_read_b128 v[68:71], v210 offset:160
    ds_read_b128 v[72:75], v210 offset:192
    ds_read_b128 v[76:79], v210 offset:224
    v_pk_mul_f32 v[122:123], v[120:121], v[176:177] op_sel:[0,0] op_sel_hi:[1,0]
    v_pk_fma_f32 v[122:123], v[120:121], v[176:177], v[122:123] op_sel:[1,1,0] op_sel_hi:[0,1,1] neg_lo:[0,1,0]
    v_pk_mul_f32 v[124:125], v[122:123], v[176:177] op_sel:[0,0] op_sel_hi:[1,0]
    v_pk_fma_f32 v[124:125], v[122:123], v[176:177], v[124:125] op_sel:[1,1,0] op_sel_hi:[0,1,1] neg_lo:[0,1,0]
    v_pk_mul_f32 v[126:127], v[124:125], v[176:177] op_sel:[0,0] op_sel_hi:[1,0]
    v_pk_fma_f32 v[126:127], v[124:125], v[176:177], v[126:127] op_sel:[1,1,0] op_sel_hi:[0,1,1] neg_lo:[0,1,0]
    v_pk_mul_f32 v[128:129], v[194:195], v[180:181] op_sel:[0,0] op_sel_hi:[1,0]
    v_pk_fma_f32 v[128:129], v[194:195], v[180:181], v[128:129] op_sel:[1,1,0] op_sel_hi:[0,1,1] neg_lo:[0,1,0]
    v_pk_mul_f32 v[130:131], v[116:117], v[180:181] op_sel:[0,0] op_sel_hi:[1,0]
    v_pk_fma_f32 v[130:131], v[116:117], v[180:181], v[130:131] op_sel:[1,1,0] op_sel_hi:[0,1,1] neg_lo:[0,1,0]
    v_pk_mul_f32 v[132:133], v[120:121], v[180:181] op_sel:[0,0] op_sel_hi:[1,0]
    v_pk_fma_f32 v[132:133], v[120:121], v[180:181], v[132:133] op_sel:[1,1,0] op_sel_hi:[0,1,1] neg_lo:[0,1,0]
    v_pk_mul_f32 v[134:135], v[124:125], v[180:181] op_sel:[0,0] op_sel_hi:[1,0]
    v_pk_fma_f32 v[134:135], v[124:125], v[180:181], v[134:135] op_sel:[1,1,0] op_sel_hi:[0,1,1] neg_lo:[0,1,0]
    v_pk_mul_f32 v[136:137], v[128:129], v[180:181] op_sel:[0,0] op_sel_hi:[1,0]
    v_pk_fma_f32 v[136:137], v[128:129], v[180:181], v[136:137] op_sel:[1,1,0] op_sel_hi:[0,1,1] neg_lo:[0,1,0]
    v_pk_mul_f32 v[138:139], v[132:133], v[180:181] op_sel:[0,0] op_sel_hi:[1,0]
    v_pk_fma_f32 v[138:139], v[132:133], v[180:181], v[138:139] op_sel:[1,1,0] op_sel_hi:[0,1,1] neg_lo:[0,1,0]
    v_pk_mul_f32 v[140:141], v[136:137], v[180:181] op_sel:[0,0] op_sel_hi:[1,0]
    v_pk_fma_f32 v[140:141], v[136:137], v[180:181], v[140:141] op_sel:[1,1,0] op_sel_hi:[0,1,1] neg_lo:[0,1,0]
    v_pk_mul_f32 v[142:143], v[138:139], v[180:181] op_sel:[0,0] op_sel_hi:[1,0]
    v_pk_fma_f32 v[142:143], v[138:139], v[180:181], v[142:143] op_sel:[1,1,0] op_sel_hi:[0,1,1] neg_lo:[0,1,0]
    v_pk_mul_f32 v[144:145], v[140:141], v[180:181] op_sel:[0,0] op_sel_hi:[1,0]
    v_pk_fma_f32 v[144:145], v[140:141], v[180:181], v[144:145] op_sel:[1,1,0] op_sel_hi:[0,1,1] neg_lo:[0,1,0]
    v_pk_mul_f32 v[146:147], v[144:145], v[180:181] op_sel:[0,0] op_sel_hi:[1,0]
    v_pk_fma_f32 v[146:147], v[144:145], v[180:181], v[146:147] op_sel:[1,1,0] op_sel_hi:[0,1,1] neg_lo:[0,1,0]
    v_pk_mul_f32 v[148:149], v[146:147], v[180:181] op_sel:[0,0] op_sel_hi:[1,0]
    v_pk_fma_f32 v[148:149], v[146:147], v[180:181], v[148:149] op_sel:[1,1,0] op_sel_hi:[0,1,1] neg_lo:[0,1,0]
    v_pk_mul_f32 v[150:151], v[148:149], v[180:181] op_sel:[0,0] op_sel_hi:[1,0]
    v_pk_fma_f32 v[150:151], v[148:149], v[180:181], v[150:151] op_sel:[1,1,0] op_sel_hi:[0,1,1] neg_lo:[0,1,0]
    v_pk_mul_f32 v[152:153], v[150:151], v[180:181] op_sel:[0,0] op_sel_hi:[1,0]
    v_pk_fma_f32 v[152:153], v[150:151], v[180:181], v[152:153] op_sel:[1,1,0] op_sel_hi:[0,1,1] neg_lo:[0,1,0]
    v_cvt_pk_bf16_f32 v194, v194, -v195
    v_cvt_pk_bf16_f32 v114, v114, -v115
    v_cvt_pk_bf16_f32 v116, v116, -v117
    v_cvt_pk_bf16_f32 v118, v118, -v119
    v_cvt_pk_bf16_f32 v120, v120, -v121
    v_cvt_pk_bf16_f32 v122, v122, -v123
    v_cvt_pk_bf16_f32 v124, v124, -v125
    v_cvt_pk_bf16_f32 v126, v126, -v127
    v_cvt_pk_bf16_f32 v128, v128, -v129
    v_cvt_pk_bf16_f32 v130, v130, -v131
    v_cvt_pk_bf16_f32 v132, v132, -v133
    v_cvt_pk_bf16_f32 v134, v134, -v135
    v_cvt_pk_bf16_f32 v136, v136, -v137
    v_cvt_pk_bf16_f32 v138, v138, -v139
    v_cvt_pk_bf16_f32 v140, v140, -v141
    v_cvt_pk_bf16_f32 v142, v142, -v143
    v_cvt_pk_bf16_f32 v144, v144, -v145
    v_cvt_pk_bf16_f32 v146, v146, -v147
    v_cvt_pk_bf16_f32 v148, v148, -v149
    v_cvt_pk_bf16_f32 v150, v150, -v151
    v_cvt_pk_bf16_f32 v152, v152, -v153
    ds_write_addtid_b32 v194 offset:0
    ds_write_addtid_b32 v114 offset:272
    ds_write_addtid_b32 v116 offset:544
    ds_write_addtid_b32 v118 offset:816
    ds_write_addtid_b32 v120 offset:1088
    ds_write_addtid_b32 v122 offset:1360
    ds_write_addtid_b32 v124 offset:1632
    ds_write_addtid_b32 v126 offset:1904
    ds_write_addtid_b32 v128 offset:2176
    ds_write_addtid_b32 v130 offset:2448
    ds_write_addtid_b32 v132 offset:2720
    ds_write_addtid_b32 v134 offset:2992
    ds_write_addtid_b32 v136 offset:3264
    ds_write_addtid_b32 v138 offset:3536
    ds_write_addtid_b32 v140 offset:3808
    ds_write_addtid_b32 v142 offset:4080
    ds_write_addtid_b32 v144 offset:4352
    ds_write_addtid_b32 v146 offset:4624
    ds_write_addtid_b32 v148 offset:4896
    ds_write_addtid_b32 v150 offset:5168
    ds_write_addtid_b32 v152 offset:6256
    s_waitcnt vmcnt(8)
    v_mul_f32_e64 v182, v22, v31
    s_waitcnt vmcnt(7)
    v_mul_f32 v183, v23, v30
    v_mul_f32 v184, s74, v183
    v_fma_f32 v185, v183, s74, -v184
    v_fma_f32 v185, v183, s75, v185
    v_mul_f32_e64 v186, s78, v182
    ds_read_b128 v[80:83], v210 offset:0
    ds_read_b128 v[84:87], v210 offset:32
    ds_read_b128 v[88:91], v210 offset:64
    ds_read_b128 v[92:95], v210 offset:96
    ds_read_b128 v[96:99], v210 offset:128
    ds_read_b128 v[100:103], v210 offset:160
    ds_read_b128 v[104:107], v210 offset:192
    ds_read_b128 v[108:111], v210 offset:224
    v_mul_f32_e64 v187, s78, v184
    v_mul_f32 v188, s77, v182
    v_mul_f32 v189, s77, v184
    v_exp_f32 v186, v186
    v_fract_f32 v187, v187
    v_exp_f32 v188, v188
    v_fract_f32 v189, v189
    v_exp_f32 v190, v182
    v_fract_f32 v191, v184
    v_fma_f32 v187, v185, s78, v187
    v_fma_f32 v189, v185, s77, v189
    v_add_f32 v191, v185, v191
    v_cos_f32 v178, v187
    v_sin_f32 v179, v187
    v_cos_f32 v180, v189
    v_sin_f32 v181, v189
    v_cos_f32 v176, v191
    v_sin_f32 v177, v191
    s_waitcnt vmcnt(3)
    v_pk_mul_f32 v[192:193], v[26:27], v[24:25] op_sel:[0,0] op_sel_hi:[1,0]
    v_pk_fma_f32 v[192:193], v[26:27], v[24:25], v[192:193] op_sel:[1,1,0] op_sel_hi:[0,1,1] neg_lo:[0,1,0]
    v_pk_mul_f32 v[178:179], v[178:179], v[186:187] op_sel_hi:[1,0]
    v_pk_mul_f32 v[180:181], v[180:181], v[188:189] op_sel_hi:[1,0]
    v_pk_mul_f32 v[176:177], v[176:177], v[190:191] op_sel_hi:[1,0]
    v_pk_mul_f32 v[194:195], v[192:193], v[30:31] op_sel_hi:[1,0]
    v_pk_mul_f32 v[116:117], v[178:179], v[178:179] op_sel:[0,0] op_sel_hi:[1,0]
    v_pk_fma_f32 v[116:117], v[178:179], v[178:179], v[116:117] op_sel:[1,1,0] op_sel_hi:[0,1,1] neg_lo:[0,1,0]
    v_pk_mul_f32 v[118:119], v[116:117], v[178:179] op_sel:[0,0] op_sel_hi:[1,0]
    v_pk_fma_f32 v[118:119], v[116:117], v[178:179], v[118:119] op_sel:[1,1,0] op_sel_hi:[0,1,1] neg_lo:[0,1,0]
    v_pk_mul_f32 v[120:121], v[118:119], v[178:179] op_sel:[0,0] op_sel_hi:[1,0]
    v_pk_fma_f32 v[120:121], v[118:119], v[178:179], v[120:121] op_sel:[1,1,0] op_sel_hi:[0,1,1] neg_lo:[0,1,0]
    v_pk_mul_f32 v[122:123], v[120:121], v[178:179] op_sel:[0,0] op_sel_hi:[1,0]
    v_pk_fma_f32 v[122:123], v[120:121], v[178:179], v[122:123] op_sel:[1,1,0] op_sel_hi:[0,1,1] neg_lo:[0,1,0]
    v_pk_mul_f32 v[124:125], v[122:123], v[178:179] op_sel:[0,0] op_sel_hi:[1,0]
    v_pk_fma_f32 v[124:125], v[122:123], v[178:179], v[124:125] op_sel:[1,1,0] op_sel_hi:[0,1,1] neg_lo:[0,1,0]
    v_pk_mul_f32 v[126:127], v[124:125], v[178:179] op_sel:[0,0] op_sel_hi:[1,0]
    v_pk_fma_f32 v[126:127], v[124:125], v[178:179], v[126:127] op_sel:[1,1,0] op_sel_hi:[0,1,1] neg_lo:[0,1,0]
    v_pk_mul_f32 v[128:129], v[126:127], v[178:179] op_sel:[0,0] op_sel_hi:[1,0]
    v_pk_fma_f32 v[128:129], v[126:127], v[178:179], v[128:129] op_sel:[1,1,0] op_sel_hi:[0,1,1] neg_lo:[0,1,0]
    v_pk_mul_f32 v[130:131], v[128:129], v[178:179] op_sel:[0,0] op_sel_hi:[1,0]
    v_pk_fma_f32 v[130:131], v[128:129], v[178:179], v[130:131] op_sel:[1,1,0] op_sel_hi:[0,1,1] neg_lo:[0,1,0]
    v_pk_mul_f32 v[132:133], v[130:131], v[178:179] op_sel:[0,0] op_sel_hi:[1,0]
    v_pk_fma_f32 v[132:133], v[130:131], v[178:179], v[132:133] op_sel:[1,1,0] op_sel_hi:[0,1,1] neg_lo:[0,1,0]
    v_pk_mul_f32 v[134:135], v[132:133], v[178:179] op_sel:[0,0] op_sel_hi:[1,0]
    v_pk_fma_f32 v[134:135], v[132:133], v[178:179], v[134:135] op_sel:[1,1,0] op_sel_hi:[0,1,1] neg_lo:[0,1,0]
    v_pk_mul_f32 v[136:137], v[134:135], v[178:179] op_sel:[0,0] op_sel_hi:[1,0]
    v_pk_fma_f32 v[136:137], v[134:135], v[178:179], v[136:137] op_sel:[1,1,0] op_sel_hi:[0,1,1] neg_lo:[0,1,0]
    v_pk_mul_f32 v[138:139], v[136:137], v[178:179] op_sel:[0,0] op_sel_hi:[1,0]
    v_pk_fma_f32 v[138:139], v[136:137], v[178:179], v[138:139] op_sel:[1,1,0] op_sel_hi:[0,1,1] neg_lo:[0,1,0]
    v_pk_mul_f32 v[140:141], v[138:139], v[178:179] op_sel:[0,0] op_sel_hi:[1,0]
    v_pk_fma_f32 v[140:141], v[138:139], v[178:179], v[140:141] op_sel:[1,1,0] op_sel_hi:[0,1,1] neg_lo:[0,1,0]
    v_pk_mul_f32 v[142:143], v[140:141], v[178:179] op_sel:[0,0] op_sel_hi:[1,0]
    v_pk_fma_f32 v[142:143], v[140:141], v[178:179], v[142:143] op_sel:[1,1,0] op_sel_hi:[0,1,1] neg_lo:[0,1,0]
    v_pk_mul_f32 v[144:145], v[142:143], v[178:179] op_sel:[0,0] op_sel_hi:[1,0]
    v_pk_fma_f32 v[144:145], v[142:143], v[178:179], v[144:145] op_sel:[1,1,0] op_sel_hi:[0,1,1] neg_lo:[0,1,0]
    v_pk_mul_f32 v[146:147], v[144:145], v[178:179] op_sel:[0,0] op_sel_hi:[1,0]
    v_pk_fma_f32 v[146:147], v[144:145], v[178:179], v[146:147] op_sel:[1,1,0] op_sel_hi:[0,1,1] neg_lo:[0,1,0]
    v_pk_mul_f32 v[148:149], v[146:147], v[178:179] op_sel:[0,0] op_sel_hi:[1,0]
    v_pk_fma_f32 v[148:149], v[146:147], v[178:179], v[148:149] op_sel:[1,1,0] op_sel_hi:[0,1,1] neg_lo:[0,1,0]
    v_pk_mul_f32 v[150:151], v[148:149], v[178:179] op_sel:[0,0] op_sel_hi:[1,0]
    v_pk_fma_f32 v[150:151], v[148:149], v[178:179], v[150:151] op_sel:[1,1,0] op_sel_hi:[0,1,1] neg_lo:[0,1,0]
    v_pk_mul_f32 v[152:153], v[150:151], v[178:179] op_sel:[0,0] op_sel_hi:[1,0]
    v_pk_fma_f32 v[152:153], v[150:151], v[178:179], v[152:153] op_sel:[1,1,0] op_sel_hi:[0,1,1] neg_lo:[0,1,0]
    v_pk_mul_f32 v[154:155], v[152:153], v[178:179] op_sel:[0,0] op_sel_hi:[1,0]
    v_pk_fma_f32 v[154:155], v[152:153], v[178:179], v[154:155] op_sel:[1,1,0] op_sel_hi:[0,1,1] neg_lo:[0,1,0]
    v_pk_mul_f32 v[156:157], v[154:155], v[178:179] op_sel:[0,0] op_sel_hi:[1,0]
    v_pk_fma_f32 v[156:157], v[154:155], v[178:179], v[156:157] op_sel:[1,1,0] op_sel_hi:[0,1,1] neg_lo:[0,1,0]
    v_pk_mul_f32 v[158:159], v[156:157], v[178:179] op_sel:[0,0] op_sel_hi:[1,0]
    v_pk_fma_f32 v[158:159], v[156:157], v[178:179], v[158:159] op_sel:[1,1,0] op_sel_hi:[0,1,1] neg_lo:[0,1,0]
    v_pk_mul_f32 v[160:161], v[158:159], v[178:179] op_sel:[0,0] op_sel_hi:[1,0]
    v_pk_fma_f32 v[160:161], v[158:159], v[178:179], v[160:161] op_sel:[1,1,0] op_sel_hi:[0,1,1] neg_lo:[0,1,0]
    v_pk_mul_f32 v[162:163], v[160:161], v[178:179] op_sel:[0,0] op_sel_hi:[1,0]
    v_pk_fma_f32 v[162:163], v[160:161], v[178:179], v[162:163] op_sel:[1,1,0] op_sel_hi:[0,1,1] neg_lo:[0,1,0]
    v_pk_mul_f32 v[164:165], v[162:163], v[178:179] op_sel:[0,0] op_sel_hi:[1,0]
    v_pk_fma_f32 v[164:165], v[162:163], v[178:179], v[164:165] op_sel:[1,1,0] op_sel_hi:[0,1,1] neg_lo:[0,1,0]
    v_pk_mul_f32 v[166:167], v[164:165], v[178:179] op_sel:[0,0] op_sel_hi:[1,0]
    v_pk_fma_f32 v[166:167], v[164:165], v[178:179], v[166:167] op_sel:[1,1,0] op_sel_hi:[0,1,1] neg_lo:[0,1,0]
    v_pk_mul_f32 v[168:169], v[166:167], v[178:179] op_sel:[0,0] op_sel_hi:[1,0]
    v_pk_fma_f32 v[168:169], v[166:167], v[178:179], v[168:169] op_sel:[1,1,0] op_sel_hi:[0,1,1] neg_lo:[0,1,0]
    v_pk_mul_f32 v[170:171], v[168:169], v[178:179] op_sel:[0,0] op_sel_hi:[1,0]
    v_pk_fma_f32 v[170:171], v[168:169], v[178:179], v[170:171] op_sel:[1,1,0] op_sel_hi:[0,1,1] neg_lo:[0,1,0]
    v_pk_mul_f32 v[172:173], v[170:171], v[178:179] op_sel:[0,0] op_sel_hi:[1,0]
    v_pk_fma_f32 v[172:173], v[170:171], v[178:179], v[172:173] op_sel:[1,1,0] op_sel_hi:[0,1,1] neg_lo:[0,1,0]
    v_pk_mul_f32 v[174:175], v[172:173], v[178:179] op_sel:[0,0] op_sel_hi:[1,0]
    v_pk_fma_f32 v[174:175], v[172:173], v[178:179], v[174:175] op_sel:[1,1,0] op_sel_hi:[0,1,1] neg_lo:[0,1,0]
    v_mov_b32 v112, 0x3f80
    v_cvt_pk_bf16_f32 v114, v178, v179
    v_cvt_pk_bf16_f32 v116, v116, v117
    v_cvt_pk_bf16_f32 v118, v118, v119
    v_cvt_pk_bf16_f32 v120, v120, v121
    v_cvt_pk_bf16_f32 v122, v122, v123
    v_cvt_pk_bf16_f32 v124, v124, v125
    v_cvt_pk_bf16_f32 v126, v126, v127
    v_cvt_pk_bf16_f32 v128, v128, v129
    v_cvt_pk_bf16_f32 v130, v130, v131
    v_cvt_pk_bf16_f32 v132, v132, v133
    v_cvt_pk_bf16_f32 v134, v134, v135
    v_cvt_pk_bf16_f32 v136, v136, v137
    v_cvt_pk_bf16_f32 v138, v138, v139
    v_cvt_pk_bf16_f32 v140, v140, v141
    v_cvt_pk_bf16_f32 v142, v142, v143
    v_cvt_pk_bf16_f32 v144, v144, v145
    v_cvt_pk_bf16_f32 v146, v146, v147
    buffer_load_dword v2, v209, s[68:71], s86 offen sc1
    s_waitcnt lgkmcnt(7)
    v_mfma_f32_32x32x16_bf16 v[32:47], v[80:83], v[48:51], v[32:47]
    s_nop 0
    ds_write_addtid_b32 v112 offset:0
    ds_write_addtid_b32 v114 offset:272
    ds_write_addtid_b32 v116 offset:544
    ds_write_addtid_b32 v118 offset:816
    v_cvt_pk_bf16_f32 v148, v148, v149
    v_cvt_pk_bf16_f32 v150, v150, v151
    s_waitcnt lgkmcnt(10)
    v_mfma_f32_32x32x16_bf16 v[32:47], v[84:87], v[52:55], v[32:47]
    s_nop 0
    ds_write_addtid_b32 v120 offset:1088
    ds_write_addtid_b32 v122 offset:1360
    ds_write_addtid_b32 v124 offset:1632
    ds_write_addtid_b32 v126 offset:1904
    v_cvt_pk_bf16_f32 v152, v152, v153
    v_cvt_pk_bf16_f32 v154, v154, v155
    s_waitcnt lgkmcnt(13)
    v_mfma_f32_32x32x16_bf16 v[32:47], v[88:91], v[56:59], v[32:47]
    s_nop 0
    ds_write_addtid_b32 v128 offset:2176
    ds_write_addtid_b32 v130 offset:2448
    ds_write_addtid_b32 v132 offset:2720
    ds_write_addtid_b32 v134 offset:2992
    v_cvt_pk_bf16_f32 v156, v156, v157
    v_cvt_pk_bf16_f32 v158, v158, v159
    s_waitcnt lgkmcnt(14)
    v_mfma_f32_32x32x16_bf16 v[32:47], v[92:95], v[60:63], v[32:47]
    s_nop 0
    ds_write_addtid_b32 v136 offset:3264
    ds_write_addtid_b32 v138 offset:3536
    ds_write_addtid_b32 v140 offset:3808
    ds_write_addtid_b32 v142 offset:4080
    v_cvt_pk_bf16_f32 v160, v160, v161
    v_cvt_pk_bf16_f32 v162, v162, v163
    v_mfma_f32_32x32x16_bf16 v[32:47], v[96:99], v[64:67], v[32:47]
    ds_write_addtid_b32 v144 offset:4352
    ds_write_addtid_b32 v146 offset:4624
    ds_write_addtid_b32 v148 offset:4896
    ds_write_addtid_b32 v150 offset:5168
    v_cvt_pk_bf16_f32 v164, v164, v165
    v_cvt_pk_bf16_f32 v166, v166, v167
    v_mfma_f32_32x32x16_bf16 v[32:47], v[100:103], v[68:71], v[32:47]
    ds_write_addtid_b32 v152 offset:5440
    ds_write_addtid_b32 v154 offset:5712
    ds_write_addtid_b32 v156 offset:5984
    ds_write_addtid_b32 v158 offset:6256
    v_cvt_pk_bf16_f32 v168, v168, v169
    v_cvt_pk_bf16_f32 v170, v170, v171
    s_waitcnt lgkmcnt(14)
    v_mfma_f32_32x32x16_bf16 v[32:47], v[104:107], v[72:75], v[32:47]
    s_nop 0
    ds_write_addtid_b32 v160 offset:6528
    ds_write_addtid_b32 v162 offset:6800
    ds_write_addtid_b32 v164 offset:7072
    ds_write_addtid_b32 v166 offset:7344
    v_cvt_pk_bf16_f32 v172, v172, v173
    v_cvt_pk_bf16_f32 v174, v174, v175
    v_mfma_f32_32x32x16_bf16 v[32:47], v[108:111], v[76:79], v[32:47]
    ds_write_addtid_b32 v168 offset:7616
    ds_write_addtid_b32 v170 offset:7888
    ds_write_addtid_b32 v172 offset:8160
    ds_write_addtid_b32 v174 offset:8432
    v_pk_mul_f32 v[114:115], v[194:195], v[176:177] op_sel:[0,0] op_sel_hi:[1,0]
    v_pk_fma_f32 v[114:115], v[194:195], v[176:177], v[114:115] op_sel:[1,1,0] op_sel_hi:[0,1,1] neg_lo:[0,1,0]
    v_pk_mul_f32 v[116:117], v[114:115], v[176:177] op_sel:[0,0] op_sel_hi:[1,0]
    v_pk_fma_f32 v[116:117], v[114:115], v[176:177], v[116:117] op_sel:[1,1,0] op_sel_hi:[0,1,1] neg_lo:[0,1,0]
    v_pk_mul_f32 v[118:119], v[116:117], v[176:177] op_sel:[0,0] op_sel_hi:[1,0]
    v_pk_fma_f32 v[118:119], v[116:117], v[176:177], v[118:119] op_sel:[1,1,0] op_sel_hi:[0,1,1] neg_lo:[0,1,0]
    v_pk_mul_f32 v[120:121], v[118:119], v[176:177] op_sel:[0,0] op_sel_hi:[1,0]
    v_pk_fma_f32 v[120:121], v[118:119], v[176:177], v[120:121] op_sel:[1,1,0] op_sel_hi:[0,1,1] neg_lo:[0,1,0]
    ds_read_b128 v[48:51], v210 offset:0
    ds_read_b128 v[52:55], v210 offset:32
    ds_read_b128 v[56:59], v210 offset:64
    ds_read_b128 v[60:63], v210 offset:96
    ds_read_b128 v[64:67], v210 offset:128
    ds_read_b128 v[68:71], v210 offset:160
    ds_read_b128 v[72:75], v210 offset:192
    ds_read_b128 v[76:79], v210 offset:224
    v_pk_mul_f32 v[122:123], v[120:121], v[176:177] op_sel:[0,0] op_sel_hi:[1,0]
    v_pk_fma_f32 v[122:123], v[120:121], v[176:177], v[122:123] op_sel:[1,1,0] op_sel_hi:[0,1,1] neg_lo:[0,1,0]
    v_pk_mul_f32 v[124:125], v[122:123], v[176:177] op_sel:[0,0] op_sel_hi:[1,0]
    v_pk_fma_f32 v[124:125], v[122:123], v[176:177], v[124:125] op_sel:[1,1,0] op_sel_hi:[0,1,1] neg_lo:[0,1,0]
    v_pk_mul_f32 v[126:127], v[124:125], v[176:177] op_sel:[0,0] op_sel_hi:[1,0]
    v_pk_fma_f32 v[126:127], v[124:125], v[176:177], v[126:127] op_sel:[1,1,0] op_sel_hi:[0,1,1] neg_lo:[0,1,0]
    v_pk_mul_f32 v[128:129], v[194:195], v[180:181] op_sel:[0,0] op_sel_hi:[1,0]
    v_pk_fma_f32 v[128:129], v[194:195], v[180:181], v[128:129] op_sel:[1,1,0] op_sel_hi:[0,1,1] neg_lo:[0,1,0]
    v_pk_mul_f32 v[130:131], v[116:117], v[180:181] op_sel:[0,0] op_sel_hi:[1,0]
    v_pk_fma_f32 v[130:131], v[116:117], v[180:181], v[130:131] op_sel:[1,1,0] op_sel_hi:[0,1,1] neg_lo:[0,1,0]
    v_pk_mul_f32 v[132:133], v[120:121], v[180:181] op_sel:[0,0] op_sel_hi:[1,0]
    v_pk_fma_f32 v[132:133], v[120:121], v[180:181], v[132:133] op_sel:[1,1,0] op_sel_hi:[0,1,1] neg_lo:[0,1,0]
    v_pk_mul_f32 v[134:135], v[124:125], v[180:181] op_sel:[0,0] op_sel_hi:[1,0]
    v_pk_fma_f32 v[134:135], v[124:125], v[180:181], v[134:135] op_sel:[1,1,0] op_sel_hi:[0,1,1] neg_lo:[0,1,0]
    v_pk_mul_f32 v[136:137], v[128:129], v[180:181] op_sel:[0,0] op_sel_hi:[1,0]
    v_pk_fma_f32 v[136:137], v[128:129], v[180:181], v[136:137] op_sel:[1,1,0] op_sel_hi:[0,1,1] neg_lo:[0,1,0]
    v_pk_mul_f32 v[138:139], v[132:133], v[180:181] op_sel:[0,0] op_sel_hi:[1,0]
    v_pk_fma_f32 v[138:139], v[132:133], v[180:181], v[138:139] op_sel:[1,1,0] op_sel_hi:[0,1,1] neg_lo:[0,1,0]
    v_pk_mul_f32 v[140:141], v[136:137], v[180:181] op_sel:[0,0] op_sel_hi:[1,0]
    v_pk_fma_f32 v[140:141], v[136:137], v[180:181], v[140:141] op_sel:[1,1,0] op_sel_hi:[0,1,1] neg_lo:[0,1,0]
    v_pk_mul_f32 v[142:143], v[138:139], v[180:181] op_sel:[0,0] op_sel_hi:[1,0]
    v_pk_fma_f32 v[142:143], v[138:139], v[180:181], v[142:143] op_sel:[1,1,0] op_sel_hi:[0,1,1] neg_lo:[0,1,0]
    v_pk_mul_f32 v[144:145], v[140:141], v[180:181] op_sel:[0,0] op_sel_hi:[1,0]
    v_pk_fma_f32 v[144:145], v[140:141], v[180:181], v[144:145] op_sel:[1,1,0] op_sel_hi:[0,1,1] neg_lo:[0,1,0]
    v_pk_mul_f32 v[146:147], v[144:145], v[180:181] op_sel:[0,0] op_sel_hi:[1,0]
    v_pk_fma_f32 v[146:147], v[144:145], v[180:181], v[146:147] op_sel:[1,1,0] op_sel_hi:[0,1,1] neg_lo:[0,1,0]
    v_pk_mul_f32 v[148:149], v[146:147], v[180:181] op_sel:[0,0] op_sel_hi:[1,0]
    v_pk_fma_f32 v[148:149], v[146:147], v[180:181], v[148:149] op_sel:[1,1,0] op_sel_hi:[0,1,1] neg_lo:[0,1,0]
    v_pk_mul_f32 v[150:151], v[148:149], v[180:181] op_sel:[0,0] op_sel_hi:[1,0]
    v_pk_fma_f32 v[150:151], v[148:149], v[180:181], v[150:151] op_sel:[1,1,0] op_sel_hi:[0,1,1] neg_lo:[0,1,0]
    v_pk_mul_f32 v[152:153], v[150:151], v[180:181] op_sel:[0,0] op_sel_hi:[1,0]
    v_pk_fma_f32 v[152:153], v[150:151], v[180:181], v[152:153] op_sel:[1,1,0] op_sel_hi:[0,1,1] neg_lo:[0,1,0]
    v_cvt_pk_bf16_f32 v194, v194, -v195
    v_cvt_pk_bf16_f32 v114, v114, -v115
    v_cvt_pk_bf16_f32 v116, v116, -v117
    v_cvt_pk_bf16_f32 v118, v118, -v119
    v_cvt_pk_bf16_f32 v120, v120, -v121
    v_cvt_pk_bf16_f32 v122, v122, -v123
    v_cvt_pk_bf16_f32 v124, v124, -v125
    v_cvt_pk_bf16_f32 v126, v126, -v127
    v_cvt_pk_bf16_f32 v128, v128, -v129
    v_cvt_pk_bf16_f32 v130, v130, -v131
    v_cvt_pk_bf16_f32 v132, v132, -v133
    v_cvt_pk_bf16_f32 v134, v134, -v135
    v_cvt_pk_bf16_f32 v136, v136, -v137
    v_cvt_pk_bf16_f32 v138, v138, -v139
    v_cvt_pk_bf16_f32 v140, v140, -v141
    v_cvt_pk_bf16_f32 v142, v142, -v143
    v_cvt_pk_bf16_f32 v144, v144, -v145
    v_cvt_pk_bf16_f32 v146, v146, -v147
    v_cvt_pk_bf16_f32 v148, v148, -v149
    v_cvt_pk_bf16_f32 v150, v150, -v151
    v_cvt_pk_bf16_f32 v152, v152, -v153
    s_waitcnt vmcnt(0)
    v_cmp_ne_u32 vcc, s50, v2
    s_nop 0
    s_cmp_lg_u64 vcc, 0
    s_cbranch_scc1 L_slow_y0
L_ok_y0:
    s_nop 0
    buffer_load_dwordx4 v[252:255], v233, s[68:71], s83 offen sc1
    buffer_load_dwordx4 a[0:3], v1, s[68:71], s94 offen offset:0 sc1
    buffer_load_dwordx4 a[4:7], v1, s[68:71], s94 offen offset:1024 sc1
    buffer_load_dwordx4 a[8:11], v1, s[68:71], s94 offen offset:2048 sc1
    ds_write_addtid_b32 v194 offset:0
    ds_write_addtid_b32 v114 offset:272
    ds_write_addtid_b32 v116 offset:544
    ds_write_addtid_b32 v118 offset:816
    ds_write_addtid_b32 v120 offset:1088
    ds_write_addtid_b32 v122 offset:1360
    ds_write_addtid_b32 v124 offset:1632
    ds_write_addtid_b32 v126 offset:1904
    ds_write_addtid_b32 v128 offset:2176
    ds_write_addtid_b32 v130 offset:2448
    ds_write_addtid_b32 v132 offset:2720
    ds_write_addtid_b32 v134 offset:2992
    ds_write_addtid_b32 v136 offset:3264
    ds_write_addtid_b32 v138 offset:3536
    ds_write_addtid_b32 v140 offset:3808
    ds_write_addtid_b32 v142 offset:4080
    ds_write_addtid_b32 v144 offset:4352
    ds_write_addtid_b32 v146 offset:4624
    ds_write_addtid_b32 v148 offset:4896
    ds_write_addtid_b32 v150 offset:5168
    ds_write_addtid_b32 v152 offset:6256
    buffer_load_dwordx4 a[12:15], v1, s[68:71], s94 offen offset:3072 sc1
    s_add_u32 s94, s94, 4096
    buffer_load_dwordx4 a[16:19], v1, s[68:71], s94 offen offset:0 sc1
    buffer_load_dwordx4 a[20:23], v1, s[68:71], s94 offen offset:1024 sc1
    buffer_load_dwordx4 a[24:27], v1, s[68:71], s94 offen offset:2048 sc1
    buffer_load_dwordx4 a[28:31], v1, s[68:71], s94 offen offset:3072 sc1
    ds_read_b128 v[80:83], v210 offset:0
    ds_read_b128 v[84:87], v210 offset:32
    ds_read_b128 v[88:91], v210 offset:64
    ds_read_b128 v[92:95], v210 offset:96
    ds_read_b128 v[96:99], v210 offset:128
    ds_read_b128 v[100:103], v210 offset:160
    ds_read_b128 v[104:107], v210 offset:192
    ds_read_b128 v[108:111], v210 offset:224
    s_waitcnt lgkmcnt(0)
    s_branch L_g1
L_w3:
    v_mov_b32 v206, s50
L_spa:
    ds_read_b128 v[4:7], v211
    s_waitcnt lgkmcnt(0)
    v_and_b32 v4, v4, v5
    v_and_b32_e64 v4, v4, v6
    s_nop 0
    v_readfirstlane_b32 s7, v4
    s_nop 0
    s_cmp_eq_u32 s7, 0
    s_cbranch_scc1 L_spa
    ds_read_b128 v[110:113], v196 offset:0
    ds_read_b128 v[114:117], v196 offset:128
    ds_read_b128 v[118:121], v196 offset:256
    ds_read_b128 v[122:125], v196 offset:384
    ds_read_b128 v[126:129], v196 offset:512
    ds_read_b128 v[130:133], v196 offset:640
    ds_read_b128 v[134:137], v196 offset:768
    ds_read_b128 v[138:141], v196 offset:896
    ds_read_b128 v[142:145], v196 offset:1024
    ds_read_b128 v[146:149], v196 offset:1152
    ds_read_b128 v[150:153], v196 offset:1280
    s_waitcnt lgkmcnt(10)
    buffer_store_dwordx4 v[110:113], v197, s[68:71], s15 offen sc1
    s_add_u32 s15, s15, 4096
    s_waitcnt lgkmcnt(9)
    buffer_store_dwordx4 v[114:117], v197, s[68:71], s15 offen sc1
    s_add_u32 s15, s15, 4096
    s_waitcnt lgkmcnt(8)
    buffer_store_dwordx4 v[118:121], v197, s[68:71], s15 offen sc1
    s_add_u32 s15, s15, 4096
    s_waitcnt lgkmcnt(7)
    buffer_store_dwordx4 v[122:125], v197, s[68:71], s15 offen sc1
    s_add_u32 s15, s15, 4096
    s_waitcnt lgkmcnt(6)
    buffer_store_dwordx4 v[126:129], v197, s[68:71], s15 offen sc1
    s_add_u32 s15, s15, 4096
    s_waitcnt lgkmcnt(5)
    buffer_store_dwordx4 v[130:133], v197, s[68:71], s15 offen sc1
    s_add_u32 s15, s15, 4096
    s_waitcnt lgkmcnt(4)
    buffer_store_dwordx4 v[134:137], v197, s[68:71], s15 offen sc1
    s_add_u32 s15, s15, 4096
    s_waitcnt lgkmcnt(3)
    buffer_store_dwordx4 v[138:141], v197, s[68:71], s15 offen sc1
    s_add_u32 s15, s15, 4096
    s_waitcnt lgkmcnt(2)
    buffer_store_dwordx4 v[142:145], v197, s[68:71], s15 offen sc1
    s_add_u32 s15, s15, 4096
    s_waitcnt lgkmcnt(1)
    buffer_store_dwordx4 v[146:149], v197, s[68:71], s15 offen sc1
    s_add_u32 s15, s15, 4096
    s_waitcnt lgkmcnt(0)
    s_mov_b64 exec, 0xff
    buffer_store_dwordx4 v[150:153], v197, s[68:71], s15 offen sc1
    s_mov_b64 exec, -1
    s_lshl_b32 s7, s82, 1
    s_add_u32 m0, s7, 40960
    s_add_u32 s7, s80, s90
    buffer_load_dwordx4 v40, s[56:59], s7 offen offset:0 lds
    buffer_load_dwordx4 v41, s[56:59], s7 offen offset:1024 lds
    buffer_load_dwordx4 v42, s[56:59], s7 offen offset:2048 lds
    buffer_load_dwordx4 v43, s[56:59], s7 offen offset:3072 lds
    s_add_u32 m0, s82, 122880
    s_add_u32 s7, s80, s91
    s_nop 0
    buffer_load_dwordx4 v44, s[56:59], s7 offen offset:0 lds
    buffer_load_dwordx4 v45, s[56:59], s7 offen offset:1024 lds
    s_add_u32 s82, s82, 2048
    s_add_u32 s80, s80, 98304
    s_cmp_eq_u32 s82, 40960
    s_cselect_b32 s82, 0, s82
    s_cselect_b32 s80, 0, s80
    s_lshl_b32 s7, s82, 1
    s_add_u32 m0, s7, 40960
    s_add_u32 s7, s80, s90
    buffer_load_dwordx4 v40, s[56:59], s7 offen offset:0 lds
    buffer_load_dwordx4 v41, s[56:59], s7 offen offset:1024 lds
    buffer_load_dwordx4 v42, s[56:59], s7 offen offset:2048 lds
    buffer_load_dwordx4 v43, s[56:59], s7 offen offset:3072 lds
    s_add_u32 m0, s82, 122880
    s_add_u32 s7, s80, s91
    buffer_load_dwordx4 v44, s[56:59], s7 offen offset:0 lds
    s_nop 0
    buffer_load_dwordx4 v45, s[56:59], s7 offen offset:1024 lds
    s_add_u32 s82, s82, 2048
    s_add_u32 s80, s80, 98304
    s_cmp_eq_u32 s82, 40960
    s_cselect_b32 s82, 0, s82
    s_cselect_b32 s80, 0, s80
    s_lshl_b32 s7, s82, 1
    s_add_u32 m0, s7, 40960
    s_add_u32 s7, s80, s90
    buffer_load_dwordx4 v40, s[56:59], s7 offen offset:0 lds
    buffer_load_dwordx4 v41, s[56:59], s7 offen offset:1024 lds
    buffer_load_dwordx4 v42, s[56:59], s7 offen offset:2048 lds
    buffer_load_dwordx4 v43, s[56:59], s7 offen offset:3072 lds
    s_add_u32 m0, s82, 122880
    s_add_u32 s7, s80, s91
    s_nop 0
    buffer_load_dwordx4 v44, s[56:59], s7 offen offset:0 lds
    buffer_load_dwordx4 v45, s[56:59], s7 offen offset:1024 lds
    s_add_u32 s82, s82, 2048
    s_add_u32 s80, s80, 98304
    s_cmp_eq_u32 s82, 40960
    s_cselect_b32 s82, 0, s82
    s_cselect_b32 s80, 0, s80
    s_lshl_b32 s7, s82, 1
    s_add_u32 m0, s7, 40960
    s_add_u32 s7, s80, s90
    buffer_load_dwordx4 v40, s[56:59], s7 offen offset:0 lds
    buffer_load_dwordx4 v41, s[56:59], s7 offen offset:1024 lds
    buffer_load_dwordx4 v42, s[56:59], s7 offen offset:2048 lds
    buffer_load_dwordx4 v43, s[56:59], s7 offen offset:3072 lds
    s_add_u32 m0, s82, 122880
    s_add_u32 s7, s80, s91
    buffer_load_dwordx4 v44, s[56:59], s7 offen offset:0 lds
    buffer_load_dwordx4 v45, s[56:59], s7 offen offset:1024 lds
    s_add_u32 s82, s82, 2048
    s_add_u32 s80, s80, 98304
    s_cmp_eq_u32 s82, 40960
    s_cselect_b32 s82, 0, s82
    s_cselect_b32 s80, 0, s80
    s_call_b64 s[88:89], L_stub1
    s_call_b64 s[88:89], L_stub2
    s_waitcnt vmcnt(24)
    s_mov_b64 exec, 1
    buffer_store_dword v206, off, s[68:71], s81 sc1
    s_mov_b64 exec, -1
    ds_read_b64_tr_b16 v[48:49], v199 offset:26112
    ds_read_b64_tr_b16 v[50:51], v199 offset:28160
    ds_read_b64_tr_b16 v[52:53], v199 offset:26144
    ds_read_b64_tr_b16 v[54:55], v199 offset:28192
    ds_read_b64_tr_b16 v[56:57], v199 offset:26176
    ds_read_b64_tr_b16 v[58:59], v199 offset:28224
    ds_read_b64_tr_b16 v[60:61], v199 offset:26208
    ds_read_b64_tr_b16 v[62:63], v199 offset:28256
    ds_read_b64_tr_b16 v[64:65], v199 offset:26240
    ds_read_b64_tr_b16 v[66:67], v199 offset:28288
    ds_read_b64_tr_b16 v[68:69], v199 offset:26272
    ds_read_b64_tr_b16 v[70:71], v199 offset:28320
    ds_read_b64_tr_b16 v[72:73], v199 offset:26304
    ds_read_b64_tr_b16 v[74:75], v199 offset:28352
    ds_read_b64_tr_b16 v[76:77], v199 offset:26336
    ds_read_b64_tr_b16 v[78:79], v199 offset:28384
    s_waitcnt lgkmcnt(14)
    buffer_store_dwordx4 v[48:51], v1, s[68:71], s14 offen sc1
    s_add_u32 s14, s14, 49152
    s_waitcnt lgkmcnt(12)
    buffer_store_dwordx4 v[52:55], v1, s[68:71], s14 offen sc1
    s_add_u32 s14, s14, 49152
    s_waitcnt lgkmcnt(10)
    buffer_store_dwordx4 v[56:59], v1, s[68:71], s14 offen sc1
    s_add_u32 s14, s14, 49152
    s_waitcnt lgkmcnt(8)
    buffer_store_dwordx4 v[60:63], v1, s[68:71], s14 offen sc1
    s_add_u32 s14, s14, 49152
    s_waitcnt lgkmcnt(6)
    buffer_store_dwordx4 v[64:67], v1, s[68:71], s14 offen sc1
    s_add_u32 s14, s14, 49152
    s_waitcnt lgkmcnt(4)
    buffer_store_dwordx4 v[68:71], v1, s[68:71], s14 offen sc1
    s_add_u32 s14, s14, 49152
    s_waitcnt lgkmcnt(2)
    buffer_store_dwordx4 v[72:75], v1, s[68:71], s14 offen sc1
    s_add_u32 s14, s14, 49152
    s_waitcnt lgkmcnt(0)
    buffer_store_dwordx4 v[76:79], v1, s[68:71], s14 offen sc1
    s_lshl_b32 s7, s82, 1
    s_add_u32 m0, s7, 40960
    s_add_u32 s7, s80, s90
    buffer_load_dwordx4 v40, s[56:59], s7 offen offset:0 lds
    buffer_load_dwordx4 v41, s[56:59], s7 offen offset:1024 lds
    buffer_load_dwordx4 v42, s[56:59], s7 offen offset:2048 lds
    buffer_load_dwordx4 v43, s[56:59], s7 offen offset:3072 lds
    s_add_u32 m0, s82, 122880
    s_add_u32 s7, s80, s91
    buffer_load_dwordx4 v44, s[56:59], s7 offen offset:0 lds
    s_nop 0
    buffer_load_dwordx4 v45, s[56:59], s7 offen offset:1024 lds
    s_add_u32 s82, s82, 2048
    s_add_u32 s80, s80, 98304
    s_cmp_eq_u32 s82, 40960
    s_cselect_b32 s82, 0, s82
    s_cselect_b32 s80, 0, s80
    s_lshl_b32 s7, s82, 1
    s_add_u32 m0, s7, 40960
    s_add_u32 s7, s80, s90
    buffer_load_dwordx4 v40, s[56:59], s7 offen offset:0 lds
    buffer_load_dwordx4 v41, s[56:59], s7 offen offset:1024 lds
    buffer_load_dwordx4 v42, s[56:59], s7 offen offset:2048 lds
    buffer_load_dwordx4 v43, s[56:59], s7 offen offset:3072 lds
    s_add_u32 m0, s82, 122880
    s_add_u32 s7, s80, s91
    s_nop 0
    buffer_load_dwordx4 v44, s[56:59], s7 offen offset:0 lds
    buffer_load_dwordx4 v45, s[56:59], s7 offen offset:1024 lds
    s_add_u32 s82, s82, 2048
    s_add_u32 s80, s80, 98304
    s_cmp_eq_u32 s82, 40960
    s_cselect_b32 s82, 0, s82
    s_cselect_b32 s80, 0, s80
    s_lshl_b32 s7, s82, 1
    s_add_u32 m0, s7, 40960
    s_add_u32 s7, s80, s90
    buffer_load_dwordx4 v40, s[56:59], s7 offen offset:0 lds
    buffer_load_dwordx4 v41, s[56:59], s7 offen offset:1024 lds
    buffer_load_dwordx4 v42, s[56:59], s7 offen offset:2048 lds
    buffer_load_dwordx4 v43, s[56:59], s7 offen offset:3072 lds
    s_add_u32 m0, s82, 122880
    s_add_u32 s7, s80, s91
    buffer_load_dwordx4 v44, s[56:59], s7 offen offset:0 lds
    s_nop 0
    buffer_load_dwordx4 v45, s[56:59], s7 offen offset:1024 lds
    s_add_u32 s82, s82, 2048
    s_add_u32 s80, s80, 98304
    s_cmp_eq_u32 s82, 40960
    s_cselect_b32 s82, 0, s82
    s_cselect_b32 s80, 0, s80
    s_lshl_b32 s7, s82, 1
    s_add_u32 m0, s7, 40960
    s_add_u32 s7, s80, s90
    buffer_load_dwordx4 v40, s[56:59], s7 offen offset:0 lds
    buffer_load_dwordx4 v41, s[56:59], s7 offen offset:1024 lds
    buffer_load_dwordx4 v42, s[56:59], s7 offen offset:2048 lds
    buffer_load_dwordx4 v43, s[56:59], s7 offen offset:3072 lds
    s_add_u32 m0, s82, 122880
    s_add_u32 s7, s80, s91
    s_nop 0
    buffer_load_dwordx4 v44, s[56:59], s7 offen offset:0 lds
    buffer_load_dwordx4 v45, s[56:59], s7 offen offset:1024 lds
    s_add_u32 s82, s82, 2048
    s_add_u32 s80, s80, 98304
    s_cmp_eq_u32 s82, 40960
    s_cselect_b32 s82, 0, s82
    s_cselect_b32 s80, 0, s80
    s_lshl_b32 s7, s82, 1
    s_add_u32 m0, s7, 40960
    s_add_u32 s7, s80, s90
    buffer_load_dwordx4 v40, s[56:59], s7 offen offset:0 lds
    buffer_load_dwordx4 v41, s[56:59], s7 offen offset:1024 lds
    buffer_load_dwordx4 v42, s[56:59], s7 offen offset:2048 lds
    buffer_load_dwordx4 v43, s[56:59], s7 offen offset:3072 lds
    s_add_u32 m0, s82, 122880
    s_add_u32 s7, s80, s91
    buffer_load_dwordx4 v44, s[56:59], s7 offen offset:0 lds
    buffer_load_dwordx4 v45, s[56:59], s7 offen offset:1024 lds
    s_add_u32 s82, s82, 2048
    s_add_u32 s80, s80, 98304
    s_cmp_eq_u32 s82, 40960
    s_cselect_b32 s82, 0, s82
    s_cselect_b32 s80, 0, s80
    s_waitcnt vmcnt(30)
    s_mov_b64 exec, 1
    buffer_store_dword v206, off, s[68:71], s85 sc1
    s_mov_b64 exec, -1
    s_mov_b32 s73, 12
L_dma:
    s_waitcnt vmcnt(24)
    s_lshl_b32 s7, s82, 1
    s_add_u32 m0, s7, 40960
    s_add_u32 s7, s80, s90
    buffer_load_dwordx4 v40, s[56:59], s7 offen offset:0 lds
    buffer_load_dwordx4 v41, s[56:59], s7 offen offset:1024 lds
    buffer_load_dwordx4 v42, s[56:59], s7 offen offset:2048 lds
    buffer_load_dwordx4 v43, s[56:59], s7 offen offset:3072 lds
    s_add_u32 m0, s82, 122880
    s_add_u32 s7, s80, s91
    buffer_load_dwordx4 v44, s[56:59], s7 offen offset:0 lds
    buffer_load_dwordx4 v45, s[56:59], s7 offen offset:1024 lds
    s_add_u32 s82, s82, 2048
    s_add_u32 s80, s80, 98304
    s_cmp_eq_u32 s82, 40960
    s_cselect_b32 s82, 0, s82
    s_cselect_b32 s80, 0, s80
    s_add_u32 s73, s73, 1
    s_cmp_lt_u32 s73, 17
    s_cbranch_scc1 L_dma
    buffer_load_dword v4, v209, s[68:71], s86 offen sc1
    s_lshl_b32 s7, s82, 1
    s_add_u32 m0, s7, 40960
    s_add_u32 s7, s80, s90
    buffer_load_dwordx4 v40, s[56:59], s7 offen offset:0 lds
    buffer_load_dwordx4 v41, s[56:59], s7 offen offset:1024 lds
    buffer_load_dwordx4 v42, s[56:59], s7 offen offset:2048 lds
    buffer_load_dwordx4 v43, s[56:59], s7 offen offset:3072 lds
    s_add_u32 m0, s82, 122880
    s_add_u32 s7, s80, s91
    buffer_load_dwordx4 v44, s[56:59], s7 offen offset:0 lds
    s_nop 0
    buffer_load_dwordx4 v45, s[56:59], s7 offen offset:1024 lds
    s_add_u32 s82, s82, 2048
    s_add_u32 s80, s80, 98304
    s_cmp_eq_u32 s82, 40960
    s_cselect_b32 s82, 0, s82
    s_cselect_b32 s80, 0, s80
    s_lshl_b32 s7, s82, 1
    s_add_u32 m0, s7, 40960
    s_add_u32 s7, s80, s90
    buffer_load_dwordx4 v40, s[56:59], s7 offen offset:0 lds
    buffer_load_dwordx4 v41, s[56:59], s7 offen offset:1024 lds
    buffer_load_dwordx4 v42, s[56:59], s7 offen offset:2048 lds
    buffer_load_dwordx4 v43, s[56:59], s7 offen offset:3072 lds
    s_add_u32 m0, s82, 122880
    s_add_u32 s7, s80, s91
    s_nop 0
    buffer_load_dwordx4 v44, s[56:59], s7 offen offset:0 lds
    buffer_load_dwordx4 v45, s[56:59], s7 offen offset:1024 lds
    s_add_u32 s82, s82, 2048
    s_add_u32 s80, s80, 98304
    s_cmp_eq_u32 s82, 40960
    s_cselect_b32 s82, 0, s82
    s_cselect_b32 s80, 0, s80
    s_lshl_b32 s7, s82, 1
    s_add_u32 m0, s7, 40960
    s_add_u32 s7, s80, s90
    buffer_load_dwordx4 v40, s[56:59], s7 offen offset:0 lds
    buffer_load_dwordx4 v41, s[56:59], s7 offen offset:1024 lds
    buffer_load_dwordx4 v42, s[56:59], s7 offen offset:2048 lds
    buffer_load_dwordx4 v43, s[56:59], s7 offen offset:3072 lds
    s_add_u32 m0, s82, 122880
    s_add_u32 s7, s80, s91
    buffer_load_dwordx4 v44, s[56:59], s7 offen offset:0 lds
    buffer_load_dwordx4 v45, s[56:59], s7 offen offset:1024 lds
    s_add_u32 s82, s82, 2048
    s_add_u32 s80, s80, 98304
    s_cmp_eq_u32 s82, 40960
    s_cselect_b32 s82, 0, s82
    s_cselect_b32 s80, 0, s80
    s_waitcnt vmcnt(18)
    v_cmp_ne_u32 vcc, s50, v4
    s_nop 0
    s_cmp_lg_u64 vcc, 0
    s_cbranch_scc1 L_slow_y3
L_ok_y3:
    buffer_load_dwordx4 v[252:255], v233, s[68:71], s83 offen sc1
    buffer_load_dwordx4 a[0:3], v1, s[68:71], s94 offen offset:0 sc1
    buffer_load_dwordx4 a[4:7], v1, s[68:71], s94 offen offset:1024 sc1
    buffer_load_dwordx4 a[8:11], v1, s[68:71], s94 offen offset:2048 sc1
    buffer_load_dwordx4 a[12:15], v1, s[68:71], s94 offen offset:3072 sc1
    s_add_u32 s94, s94, 4096
    buffer_load_dwordx4 a[16:19], v1, s[68:71], s94 offen offset:0 sc1
    buffer_load_dwordx4 a[20:23], v1, s[68:71], s94 offen offset:1024 sc1
    buffer_load_dwordx4 a[24:27], v1, s[68:71], s94 offen offset:2048 sc1
    buffer_load_dwordx4 a[28:31], v1, s[68:71], s94 offen offset:3072 sc1
    s_waitcnt vmcnt(9)
L_g1:
    s_barrier
    v_mfma_f32_32x32x16_bf16 v[32:47], v[80:83], v[48:51], v[32:47]
    s_add_u32 s94, s94, 4096
    s_lshr_b32 s12, s4, 1
    s_lshl_b32 s12, s12, 3
    s_and_b32 s73, s5, 7
    s_add_u32 s12, s12, s73
    buffer_load_dwordx4 a[32:35], v1, s[68:71], s94 offen offset:0 sc1
    v_mfma_f32_32x32x16_bf16 v[32:47], v[84:87], v[52:55], v[32:47]
    s_and_b32 s13, s4, 1
    s_lshl_b32 s13, s13, 2
    s_lshr_b32 s73, s5, 3
    s_add_u32 s13, s13, s73
    s_mul_i32 s85, s13, 20
    ds_read_b64_tr_b16 v[112:113], v236 offset:0
    ds_read_b64_tr_b16 v[114:115], v236 offset:512
    v_mfma_f32_32x32x16_bf16 v[32:47], v[88:91], v[56:59], v[32:47]
    s_add_u32 s85, s85, s3
    ds_read_b64_tr_b16 v[116:117], v237 offset:0
    ds_read_b64_tr_b16 v[118:119], v237 offset:512
    ds_read_b64_tr_b16 v[120:121], v238 offset:0
    ds_read_b64_tr_b16 v[122:123], v238 offset:256
    buffer_load_dwordx4 a[36:39], v1, s[68:71], s94 offen offset:1024 sc1
    v_mfma_f32_32x32x16_bf16 v[32:47], v[92:95], v[60:63], v[32:47]
    s_mul_i32 s85, s85, 12288
    s_add_u32 s85, s85, 5373952
    s_lshr_b32 s83, s10, 3
    ds_read_b64_tr_b16 v[124:125], v236 offset:2048
    ds_read_b64_tr_b16 v[126:127], v236 offset:2560
    ds_read_b64_tr_b16 v[128:129], v237 offset:2048
    ds_read_b64_tr_b16 v[130:131], v237 offset:2560
    v_mfma_f32_32x32x16_bf16 v[32:47], v[96:99], v[64:67], v[32:47]
    s_lshl_b32 s83, s83, 9
    ds_read_b64_tr_b16 v[132:133], v238 offset:1024
    ds_read_b64_tr_b16 v[134:135], v238 offset:1280
    ds_read_b64_tr_b16 v[136:137], v236 offset:4096
    ds_read_b64_tr_b16 v[138:139], v236 offset:4608
    buffer_load_dwordx4 a[40:43], v1, s[68:71], s94 offen offset:2048 sc1
    v_mfma_f32_32x32x16_bf16 v[32:47], v[100:103], v[68:71], v[32:47]
    s_and_b32 s73, s10, 6
    ds_read_b64_tr_b16 v[140:141], v237 offset:4096
    ds_read_b64_tr_b16 v[142:143], v237 offset:4608
    ds_read_b64_tr_b16 v[144:145], v238 offset:2048
    ds_read_b64_tr_b16 v[146:147], v238 offset:2304
    v_mfma_f32_32x32x16_bf16 v[32:47], v[104:107], v[72:75], v[32:47]
    s_lshl_b32 s73, s73, 1
    s_add_u32 s83, s83, s73
    ds_read_b64_tr_b16 v[148:149], v236 offset:6144
    ds_read_b64_tr_b16 v[150:151], v236 offset:6656
    buffer_load_dwordx4 a[44:47], v1, s[68:71], s94 offen offset:3072 sc1
    s_add_u32 s94, s94, 4096
    v_mfma_f32_32x32x16_bf16 v[32:47], v[108:111], v[76:79], v[32:47]
    s_waitcnt vmcnt(12)
    s_mul_i32 s73, s3, 663552
    ds_read_b64_tr_b16 v[152:153], v237 offset:6144
    ds_read_b64_tr_b16 v[154:155], v237 offset:6656
    ds_read_b64_tr_b16 v[156:157], v238 offset:3072
    ds_read_b64_tr_b16 v[158:159], v238 offset:3328
    v_mfma_f32_32x32x16_bf16 v[48:63], v[240:243], v[252:255], 0
    s_add_u32 s83, s83, s73
    s_cmp_lt_u32 s5, 30
    s_cselect_b32 s83, s83, 1073741824
    ds_read_b64_tr_b16 v[160:161], v236 offset:8192
    ds_read_b64_tr_b16 v[162:163], v236 offset:8704
    buffer_load_dwordx4 a[48:51], v1, s[68:71], s94 offen offset:0 sc1
    v_mfma_f32_32x32x16_bf16 v[64:79], v[242:245], v[252:255], 0
    ds_read_b64_tr_b16 v[164:165], v237 offset:8192
    ds_read_b64_tr_b16 v[166:167], v237 offset:8704
    ds_read_b64_tr_b16 v[168:169], v238 offset:4096
    ds_read_b64_tr_b16 v[170:171], v238 offset:4352
    v_mfma_f32_32x32x16_bf16 v[96:111], v[244:247], v[252:255], 0
    s_waitcnt vmcnt(12) lgkmcnt(14)
    s_mul_i32 m0, s3, 4352
    s_and_b32 s96, s10, 1
    buffer_load_dwordx4 a[52:55], v1, s[68:71], s94 offen offset:1024 sc1
    v_add_f32 v32, v32, v29
    v_mov_b32_e64 v26, 0
    v_mfma_f32_32x32x16_bf16 v[48:63], v[112:115], a[0:3], v[48:63]
    s_lshl_b32 s96, s96, 4
    s_mul_i32 s73, s9, 3
    ds_read_b64_tr_b16 v[172:173], v236 offset:10240
    ds_read_b64_tr_b16 v[174:175], v236 offset:10752
    ds_read_b64_tr_b16 v[176:177], v237 offset:10240
    ds_read_b64_tr_b16 v[178:179], v237 offset:10752
    v_mov_b32 v27, 0
    v_mfma_f32_32x32x16_bf16 v[64:79], v[116:119], a[0:3], v[64:79]
    s_add_u32 s92, s92, s73
    ds_write_b128 v214, v[32:35] offset:18176
    v_mfma_f32_32x32x16_bf16 v[96:111], v[120:123], a[0:3], v[96:111]
    s_waitcnt vmcnt(12)
    s_lshl_b32 s92, s92, 10
    ds_read_b64_tr_b16 v[180:181], v238 offset:5120
    ds_read_b64_tr_b16 v[182:183], v238 offset:5376
    ds_read_b64_tr_b16 v[184:185], v236 offset:12288
    buffer_load_dwordx4 a[56:59], v1, s[68:71], s94 offen offset:2048 sc1
    v_mfma_f32_32x32x16_bf16 v[48:63], v[124:127], a[4:7], v[48:63]
    s_add_u32 s92, s92, 7340032
    s_add_u32 s93, s92, 2048
    ds_read_b64_tr_b16 v[186:187], v236 offset:12800
    ds_read_b64_tr_b16 v[188:189], v237 offset:12288
    ds_read_b64_tr_b16 v[190:191], v237 offset:12800
    ds_read_b64_tr_b16 v[112:113], v238 offset:6144
    v_mfma_f32_32x32x16_bf16 v[64:79], v[128:131], a[4:7], v[64:79]
    s_and_b32 s73, s9, 1
    ds_read_b64_tr_b16 v[114:115], v238 offset:6400
    ds_read_b64_tr_b16 v[116:117], v236 offset:14336
    ds_read_b64_tr_b16 v[118:119], v236 offset:14848
    buffer_load_dwordx4 a[60:63], v1, s[68:71], s94 offen offset:3072 sc1
    s_add_u32 s94, s94, 4096
    v_mfma_f32_32x32x16_bf16 v[96:111], v[132:135], a[4:7], v[96:111]
    s_waitcnt vmcnt(13)
    s_lshl_b32 s73, s73, 10
    ds_read_b64_tr_b16 v[120:121], v237 offset:14336
    ds_write_b64 v215, v[36:37] offset:18176
    v_mfma_f32_32x32x16_bf16 v[48:63], v[136:139], a[8:11], v[48:63]
    s_add_u32 s92, s92, s73
    s_lshl_b32 s73, s73, 1
    ds_read_b64_tr_b16 v[122:123], v237 offset:14848
    ds_read_b64_tr_b16 v[124:125], v238 offset:7168
    ds_read_b64_tr_b16 v[126:127], v238 offset:7424
    buffer_load_dwordx4 a[64:67], v1, s[68:71], s94 offen offset:0 sc1
    v_mfma_f32_32x32x16_bf16 v[64:79], v[140:143], a[8:11], v[64:79]
    s_waitcnt lgkmcnt(14)
    s_sub_u32 s93, s93, s73
    ds_read_b64_tr_b16 v[128:129], v236 offset:16384
    ds_write_b64 v216, v[38:39] offset:18176
    v_mfma_f32_32x32x16_bf16 v[96:111], v[144:147], a[8:11], v[96:111]
    s_waitcnt vmcnt(13)
    s_mul_i32 s95, s10, 4224
    s_add_u32 s95, s95, 13631488
    ds_read_b64_tr_b16 v[130:131], v236 offset:16896
    ds_read_b64_tr_b16 v[132:133], v237 offset:16384
    buffer_load_dwordx4 a[68:71], v1, s[68:71], s94 offen offset:1024 sc1
    v_mfma_f32_32x32x16_bf16 v[48:63], v[148:151], a[12:15], v[48:63]
    s_mov_b32 s84, 16785408
    s_cmp_lt_u32 s5, 30
    s_cselect_b32 s95, s95, 1073741824
    ds_read_b64_tr_b16 v[134:135], v237 offset:16896
    ds_read_b64_tr_b16 v[136:137], v238 offset:8192
    ds_read_b64_tr_b16 v[138:139], v238 offset:8448
    ds_write_addtid_b32 v40 offset:20224
    v_mfma_f32_32x32x16_bf16 v[64:79], v[152:155], a[12:15], v[64:79]
    ds_read_b64_tr_b16 v[140:141], v236 offset:18432
    ds_read_b64_tr_b16 v[142:143], v236 offset:18944
    buffer_load_dwordx4 v[2:5], v208, s[68:71], s84 offen sc1
    ds_write_addtid_b32 v41 offset:20352
    ds_write_addtid_b32 v42 offset:20480
    v_mfma_f32_32x32x16_bf16 v[96:111], v[156:159], a[12:15], v[96:111]
    s_waitcnt vmcnt(14)
    ds_read_b64_tr_b16 v[144:145], v237 offset:18432
    ds_read_b64_tr_b16 v[146:147], v237 offset:18944
    ds_write_addtid_b32 v43 offset:20608
    v_lshlrev_b32_e64 v30, 16, v252
    v_rcp_f32 v6, v30
    v_mfma_f32_32x32x16_bf16 v[48:63], v[160:163], a[16:19], v[48:63]
    ds_read_b64_tr_b16 v[148:149], v238 offset:9216
    ds_read_b64_tr_b16 v[150:151], v238 offset:9472
    ds_read_b64_tr_b16 v[152:153], v236 offset:20480
    buffer_load_dwordx4 a[72:75], v1, s[68:71], s94 offen offset:2048 sc1
    ds_write_addtid_b32 v26 offset:4096
    v_mfma_f32_32x32x16_bf16 v[64:79], v[164:167], a[16:19], v[64:79]
    ds_read_b64 v[80:81], v217 offset:20224
    ds_read_b32 v82, v217 offset:20232
    ds_read_b64_tr_b16 v[154:155], v236 offset:20992
    ds_read_b64_tr_b16 v[156:157], v237 offset:20480
    v_mov_b32 v232, s50
    v_mfma_f32_32x32x16_bf16 v[96:111], v[168:171], a[16:19], v[96:111]
    s_waitcnt vmcnt(14)
    ds_read_b64 v[84:85], v217 offset:19712
    buffer_load_dwordx4 a[76:79], v1, s[68:71], s94 offen offset:3072 sc1
    s_add_u32 s94, s94, 4096
    v_mul_f32_e64 v7, v6, v6
    v_mul_f32 v8, 0xc0135761, v6
    v_mfma_f32_32x32x16_bf16 v[48:63], v[172:175], a[20:23], v[48:63]
    ds_read_b32 v86, v217 offset:19720
    ds_read_b64 v[88:89], v217 offset:19200
    ds_read_b64_tr_b16 v[158:159], v237 offset:20992
    ds_read_b64_tr_b16 v[160:161], v238 offset:10240
    v_mul_f32 v7, v7, v6
    v_mfma_f32_32x32x16_bf16 v[64:79], v[176:179], a[20:23], v[64:79]
    s_waitcnt lgkmcnt(14)
    ds_read_b32 v90, v217 offset:19208
    ds_read_b64_tr_b16 v[162:163], v238 offset:10496
    ds_read_b64_tr_b16 v[164:165], v236 offset:22528
    buffer_load_dwordx4 a[80:83], v1, s[68:71], s94 offen offset:0 sc1
    v_mul_f32 v9, 0xbdd2d3e8, v7
    v_mfma_f32_32x32x16_bf16 v[96:111], v[180:183], a[20:23], v[96:111]
    s_waitcnt vmcnt(15)
    ds_read_b128 v[92:95], v218 offset:18176
    ds_read_b64_tr_b16 v[166:167], v236 offset:23040
    ds_read_b64_tr_b16 v[168:169], v237 offset:22528
    v_cmp_gt_u32 s[78:79], 16, v0
    v_mov_b32 v233, 0x3f80
    v_mfma_f32_32x32x16_bf16 v[48:63], v[184:187], a[24:27], v[48:63]
    s_mov_b32 s73, 1073741824
    ds_read_b64_tr_b16 v[170:171], v237 offset:23040
    ds_read_b64_tr_b16 v[172:173], v238 offset:11264
    ds_read_b64_tr_b16 v[174:175], v238 offset:11520
    ds_read_b64_tr_b16 v[176:177], v236 offset:24576
    buffer_load_dwordx4 a[84:87], v1, s[68:71], s94 offen offset:1024 sc1
    v_mfma_f32_32x32x16_bf16 v[64:79], v[188:191], a[24:27], v[64:79]
    ds_read_b64_tr_b16 v[178:179], v236 offset:25088
    ds_read_b64_tr_b16 v[180:181], v237 offset:24576
    ds_read_b64_tr_b16 v[182:183], v237 offset:25088
    ds_read_b64_tr_b16 v[184:185], v238 offset:12288
    v_cndmask_b32 v252, 0, v233, s[78:79]
    v_add_u32 v233, 0, v0
    v_mfma_f32_32x32x16_bf16 v[96:111], v[112:115], a[24:27], v[96:111]
    s_waitcnt vmcnt(15)
    ds_read_b64_tr_b16 v[186:187], v238 offset:12544
    ds_read_b64_tr_b16 v[188:189], v236 offset:26624
    ds_read_b64_tr_b16 v[190:191], v236 offset:27136
    buffer_load_dwordx4 a[88:91], v1, s[68:71], s94 offen offset:2048 sc1
    v_mul_u32_u24 v234, 5958, v233
    v_mfma_f32_32x32x16_bf16 v[48:63], v[116:119], a[28:31], v[48:63]
    ds_read_b64_tr_b16 v[112:113], v237 offset:26624
    ds_read_b64_tr_b16 v[114:115], v237 offset:27136
    ds_read_b64_tr_b16 v[116:117], v238 offset:13312
    ds_read_b64_tr_b16 v[118:119], v238 offset:13568
    v_lshrrev_b32_e64 v234, 16, v234
    v_mfma_f32_32x32x16_bf16 v[64:79], v[120:123], a[28:31], v[64:79]
    ds_read_b64_tr_b16 v[120:121], v236 offset:28672
    buffer_load_dwordx4 a[92:95], v1, s[68:71], s94 offen offset:3072 sc1
    s_add_u32 s94, s94, 4096
    v_mul_u32_u24 v235, 11, v234
    v_sub_u32 v233, v233, v235
    v_mfma_f32_32x32x16_bf16 v[96:111], v[124:127], a[28:31], v[96:111]
    s_waitcnt vmcnt(16)
    ds_read_b64_tr_b16 v[122:123], v236 offset:29184
    ds_read_b64_tr_b16 v[124:125], v237 offset:28672
    ds_read_b64_tr_b16 v[126:127], v237 offset:29184
    v_cmp_gt_u32 s[78:79], 10, v233
    v_mfma_f32_32x32x16_bf16 v[48:63], v[128:131], a[32:35], v[48:63]
    buffer_load_dwordx4 a[96:99], v1, s[68:71], s94 offen offset:0 sc1
    s_waitcnt lgkmcnt(14)
    v_cvt_pk_bf16_f32 v10, v82, v82
    v_cvt_pk_bf16_f32 v11, v82, v82
    v_cvt_pk_bf16_f32 v12, v81, v81
    v_mul_u32_u24 v234, 1280, v234
    v_mfma_f32_32x32x16_bf16 v[64:79], v[132:135], a[32:35], v[64:79]
    ds_read_b64_tr_b16 v[128:129], v238 offset:14336
    ds_read_b64_tr_b16 v[130:131], v238 offset:14592
    v_cvt_pk_bf16_f32 v13, v81, v81
    v_cvt_pk_bf16_f32 v14, v81, v81
    v_lshl_add_u32 v233, v233, 4, v234
    v_mov_b32 v234, s73
    v_mfma_f32_32x32x16_bf16 v[96:111], v[136:139], a[32:35], v[96:111]
    s_waitcnt vmcnt(16)
    ds_read_b64_tr_b16 v[132:133], v236 offset:30720
    ds_read_b64_tr_b16 v[134:135], v236 offset:31232
    buffer_load_dwordx4 a[100:103], v1, s[68:71], s94 offen offset:1024 sc1
    v_cvt_pk_bf16_f32 v15, v81, v80
    v_cndmask_b32 v229, v234, v233, s[78:79]
    v_mfma_f32_32x32x16_bf16 v[48:63], v[140:143], a[36:39], v[48:63]
    ds_read_b64_tr_b16 v[136:137], v237 offset:30720
    ds_read_b64_tr_b16 v[138:139], v237 offset:31232
    ds_read_b64_tr_b16 v[140:141], v238 offset:15360
    v_cvt_pk_bf16_f32 v16, v80, v80
    v_cvt_pk_bf16_f32 v17, v80, v80
    v_add_u32 v233, 64, v0
    v_mfma_f32_32x32x16_bf16 v[64:79], v[144:147], a[36:39], v[64:79]
    ds_read_b64_tr_b16 v[142:143], v238 offset:15616
    buffer_load_dwordx4 a[104:107], v1, s[68:71], s94 offen offset:2048 sc1
    v_cvt_pk_bf16_f32 v18, v86, v86
    v_mul_u32_u24 v234, 5958, v233
    v_lshrrev_b32_e64 v234, 16, v234
    v_mfma_f32_32x32x16_bf16 v[96:111], v[148:151], a[36:39], v[96:111]
    s_waitcnt vmcnt(17)
    ds_read_b64_tr_b16 v[144:145], v236 offset:32768
    ds_read_b64_tr_b16 v[146:147], v236 offset:33280
    ds_read_b64_tr_b16 v[148:149], v237 offset:32768
    v_cvt_pk_bf16_f32 v19, v85, v85
    v_cvt_pk_bf16_f32 v20, v85, v84
    v_mul_u32_u24 v235, 11, v234
    v_mfma_f32_32x32x16_bf16 v[48:63], v[152:155], a[40:43], v[48:63]
    buffer_load_dwordx4 a[108:111], v1, s[68:71], s94 offen offset:3072 sc1
    s_add_u32 s94, s94, 4096
    v_cvt_pk_bf16_f32 v21, v84, v84
    v_sub_u32 v233, v233, v235
    v_cmp_gt_u32 s[78:79], 10, v233
    v_mfma_f32_32x32x16_bf16 v[64:79], v[156:159], a[40:43], v[64:79]
    ds_read_b64_tr_b16 v[150:151], v237 offset:33280
    ds_read_b64_tr_b16 v[152:153], v238 offset:16384
    ds_read_b64_tr_b16 v[154:155], v238 offset:16640
    v_cvt_pk_bf16_f32 v22, v90, v89
    v_cvt_pk_bf16_f32 v23, v88, v88
    v_mul_u32_u24 v234, 1280, v234
    v_mfma_f32_32x32x16_bf16 v[96:111], v[160:163], a[40:43], v[96:111]
    s_waitcnt vmcnt(17)
    ds_read_b64_tr_b16 v[156:157], v236 offset:34816
    ds_read_b64_tr_b16 v[158:159], v236 offset:35328
    buffer_load_dwordx4 a[112:115], v1, s[68:71], s94 offen offset:0 sc1
    v_cvt_pk_bf16_f32 v24, v95, v94
    v_lshl_add_u32 v233, v233, 4, v234
    v_mfma_f32_32x32x16_bf16 v[48:63], v[164:167], a[44:47], v[48:63]
    s_nop 0
    ds_read_b64_tr_b16 v[160:161], v237 offset:34816
    ds_read_b64_tr_b16 v[162:163], v237 offset:35328
    ds_read_b64_tr_b16 v[164:165], v238 offset:17408
    v_cvt_pk_bf16_f32 v25, v93, v92
    v_mov_b32 v234, s73
    v_cndmask_b32 v230, v234, v233, s[78:79]
    v_mfma_f32_32x32x16_bf16 v[64:79], v[168:171], a[44:47], v[64:79]
    ds_write_b128 v219, v[10:13]
    v_mfma_f32_32x32x16_bf16 v[96:111], v[172:175], a[44:47], v[96:111]
    s_waitcnt vmcnt(17)
    buffer_load_dwordx4 a[116:119], v1, s[68:71], s94 offen offset:1024 sc1
    s_waitcnt vmcnt(12)
    v_cmp_ne_u64 vcc, s[50:51], v[2:3]
    v_cmp_ne_u64 s[88:89], s[50:51], v[4:5]
    s_nop 0
    s_or_b64 vcc, vcc, s[88:89]
    s_cbranch_scc1 L_slow_x
L_ok_x:
    v_mfma_f32_32x32x16_bf16 v[48:63], v[176:179], a[48:51], v[48:63]
    s_waitcnt lgkmcnt(9)
    ds_read_b64_tr_b16 v[166:167], v238 offset:17664
    ds_read_b64_tr_b16 v[168:169], v236 offset:36864
    v_add_u32 v233, 128, v0
    v_mul_u32_u24 v234, 5958, v233
    v_lshrrev_b32 v234, 16, v234
    v_mul_u32_u24 v235, 11, v234
    v_mfma_f32_32x32x16_bf16 v[64:79], v[180:183], a[48:51], v[64:79]
    ds_read_b64_tr_b16 v[170:171], v236 offset:37376
    ds_read_b64_tr_b16 v[172:173], v237 offset:36864
    ds_read_b64_tr_b16 v[174:175], v237 offset:37376
    buffer_load_dwordx4 a[120:123], v1, s[68:71], s94 offen offset:2048 sc1
    v_sub_u32 v233, v233, v235
    v_mfma_f32_32x32x16_bf16 v[96:111], v[184:187], a[48:51], v[96:111]
    ds_write_b128 v219, v[14:17] offset:16
    v_mfma_f32_32x32x16_bf16 v[48:63], v[188:191], a[52:55], v[48:63]
    ds_read_b64_tr_b16 v[176:177], v238 offset:18432
    buffer_load_dwordx2 v[192:193], v222, s[68:71], s83 offen sc1
    v_lshrrev_b32 v235, 4, v234
    v_lshl_add_u32 v233, v235, 4, v233
    v_cmp_gt_u32 s[78:79], 10, v233
    v_mfma_f32_32x32x16_bf16 v[64:79], v[112:115], a[52:55], v[64:79]
    ds_read_b64_tr_b16 v[178:179], v238 offset:18688
    ds_read_b64_tr_b16 v[180:181], v236 offset:38912
    ds_read_b64_tr_b16 v[182:183], v236 offset:39424
    ds_read_b64_tr_b16 v[184:185], v237 offset:38912
    v_mul_u32_u24 v234, 1280, v234
    v_mfma_f32_32x32x16_bf16 v[96:111], v[116:119], a[52:55], v[96:111]
    s_add_u32 s83, s83, 82944
    buffer_load_dwordx4 a[124:127], v1, s[68:71], s94 offen offset:3072 sc1
    s_add_u32 s94, s94, 4096
    ds_write_b64 v220, v[18:19] offset:2048
    v_mfma_f32_32x32x16_bf16 v[48:63], v[120:123], a[56:59], v[48:63]
    ds_read_b64_tr_b16 v[186:187], v237 offset:39424
    ds_read_b64_tr_b16 v[188:189], v238 offset:19456
    ds_read_b64_tr_b16 v[190:191], v238 offset:19712
    v_lshl_add_u32 v233, v233, 4, v234
    v_mov_b32_e64 v234, s73
    v_cndmask_b32 v231, v234, v233, s[78:79]
    v_mfma_f32_32x32x16_bf16 v[64:79], v[124:127], a[56:59], v[64:79]
    buffer_load_dwordx2 v[194:195], v222, s[68:71], s83 offen sc1
    ds_write_b64 v220, v[20:21] offset:2056
    v_and_b32_e64 v233, 3, v0
    v_mfma_f32_32x32x16_bf16 v[96:111], v[128:131], a[56:59], v[96:111]
    s_add_u32 s83, s83, 82944
    ds_read_b64_tr_b16 v[112:113], v236 offset:40960
    ds_read_b64_tr_b16 v[114:115], v236 offset:41472
    ds_read_b64_tr_b16 v[116:117], v237 offset:40960
    ds_read_b64_tr_b16 v[118:119], v237 offset:41472
    v_and_b32_e64 v234, 4, v0
    v_lshl_add_u32 v42, v233, 4, v234
    v_mfma_f32_32x32x16_bf16 v[48:63], v[132:135], a[60:63], v[48:63]
    buffer_load_dwordx4 a[128:131], v1, s[68:71], s94 offen offset:0 sc1
    ds_write_b64 v221, v[22:23] offset:3072
    v_lshlrev_b32_e64 v42, 6, v42
    v_mfma_f32_32x32x16_bf16 v[64:79], v[136:139], a[60:63], v[64:79]
    s_mul_i32 s73, s3, 5
    ds_read_b64_tr_b16 v[120:121], v238 offset:20480
    ds_read_b64_tr_b16 v[122:123], v238 offset:20736
    ds_read_b64_tr_b16 v[124:125], v236 offset:43008
    ds_read_b64_tr_b16 v[126:127], v236 offset:43520
    v_mfma_f32_32x32x16_bf16 v[96:111], v[140:143], a[60:63], v[96:111]
    s_lshr_b32 s73, s73, 1
    s_mul_i32 s73, s73, 12
    buffer_load_dwordx4 a[132:135], v1, s[68:71], s94 offen offset:1024 sc1
    ds_write_b64 v221, v[24:25] offset:3584
    v_mfma_f32_32x32x16_bf16 v[48:63], v[144:147], a[64:67], v[48:63]
    s_waitcnt lgkmcnt(11)
    ds_read_b64_tr_b16 v[128:129], v237 offset:43008
    ds_read_b64_tr_b16 v[130:131], v237 offset:43520
    ds_read_b64_tr_b16 v[132:133], v238 offset:21504
    ds_read_b64_tr_b16 v[134:135], v238 offset:21760
    v_min_u32_e64 v233, 35, v0
    v_mfma_f32_32x32x16_bf16 v[64:79], v[148:151], a[64:67], v[64:79]
    ds_read_b64_tr_b16 v[136:137], v236 offset:45056
    ds_read_b64_tr_b16 v[138:139], v236 offset:45568
    buffer_load_dwordx2 v[196:197], v222, s[68:71], s83 offen sc1
    s_add_u32 s83, s83, 82944
    v_add_lshl_u32 v43, v233, s73, 8
    v_mfma_f32_32x32x16_bf16 v[96:111], v[152:155], a[64:67], v[96:111]
    ds_read_b64_tr_b16 v[140:141], v237 offset:45056
    ds_read_b64_tr_b16 v[142:143], v237 offset:45568
    ds_read_b64_tr_b16 v[144:145], v238 offset:22528
    ds_read_b64_tr_b16 v[146:147], v238 offset:22784
    v_and_b32 v233, 15, v0
    v_lshrrev_b32 v234, 4, v0
    v_mfma_f32_32x32x16_bf16 v[48:63], v[156:159], a[68:71], v[48:63]
    s_mul_i32 s73, s13, 160
    ds_read_b64_tr_b16 v[148:149], v236 offset:47104
    ds_read_b64_tr_b16 v[150:151], v236 offset:47616
    ds_read_b64_tr_b16 v[152:153], v237 offset:47104
    ds_read_b64_tr_b16 v[154:155], v237 offset:47616
    buffer_load_dwordx4 a[136:139], v1, s[68:71], s94 offen offset:2048 sc1
    v_mfma_f32_32x32x16_bf16 v[64:79], v[160:163], a[68:71], v[64:79]
    ds_read_b64_tr_b16 v[156:157], v238 offset:23552
    ds_read_b64_tr_b16 v[158:159], v238 offset:23808
    ds_read_b64_tr_b16 v[160:161], v236 offset:49152
    ds_read_b64_tr_b16 v[162:163], v236 offset:49664
    v_lshl_add_u32 v45, v233, 1, s73
    s_lshl_b32 s14, s12, 2
    v_mfma_f32_32x32x16_bf16 v[96:111], v[164:167], a[68:71], v[96:111]
    s_waitcnt vmcnt(19)
    s_add_u32 s14, s14, s3
    ds_read_b64_tr_b16 v[164:165], v237 offset:49152
    ds_read_b64_tr_b16 v[166:167], v237 offset:49664
    buffer_load_dwordx2 v[198:199], v222, s[68:71], s83 offen sc1
    s_add_u32 s83, s83, 82944
    v_mfma_f32_32x32x16_bf16 v[48:63], v[168:171], a[72:75], v[48:63]
    s_mul_i32 s14, s14, 20480
    ds_read_b64_tr_b16 v[168:169], v238 offset:24576
    ds_read_b64_tr_b16 v[170:171], v238 offset:24832
    v_mfma_f32_32x32x16_bf16 v[64:79], v[172:175], a[72:75], v[64:79]
    s_lshl_b32 s7, s3, 10
    s_add_u32 m0, s7, 18080
    s_waitcnt lgkmcnt(0)
    s_barrier
    buffer_load_dwordx4 a[140:143], v1, s[68:71], s94 offen offset:3072 sc1
    s_add_u32 s94, s94, 4096
    v_mfma_f32_32x32x16_bf16 v[96:111], v[176:179], a[72:75], v[96:111]
    s_waitcnt vmcnt(20)
    s_add_u32 s14, s14, s73
    s_mul_i32 s15, s3, 3072
    s_add_u32 s15, s15, 122880
    ds_read_b64_tr_b16 v[172:173], v236 offset:51200
    ds_read_b64_tr_b16 v[174:175], v236 offset:51712
    ds_read_b64_tr_b16 v[176:177], v237 offset:51200
    v_mfma_f32_32x32x16_bf16 v[48:63], v[180:183], a[76:79], v[48:63]
    ds_read2_b32 v[80:81], v224 offset0:0 offset1:1
    ds_read2_b32 v[82:83], v224 offset0:64 offset1:65
    buffer_load_dwordx2 v[200:201], v222, s[68:71], s83 offen sc1
    s_add_u32 s83, s83, 82944
    v_add_u32_e64 v218, s15, v1
    v_mfma_f32_32x32x16_bf16 v[64:79], v[184:187], a[76:79], v[64:79]
    ds_read2_b32 v[84:85], v224 offset0:128 offset1:129
    ds_read2_b32 v[86:87], v224 offset0:192 offset1:193
    v_mul_u32_u24 v219, 176, v233
    v_lshl_add_u32 v235, v234, 3, s15
    v_mfma_f32_32x32x16_bf16 v[96:111], v[188:191], a[76:79], v[96:111]
    s_waitcnt vmcnt(20)
    ds_read2_b32 v[88:89], v225 offset0:0 offset1:1
    ds_read2_b32 v[90:91], v225 offset0:64 offset1:65
    buffer_load_dwordx4 a[144:147], v1, s[68:71], s94 offen offset:0 sc1
    v_add_u32 v219, v219, v235
    v_mfma_f32_32x32x16_bf16 v[48:63], v[112:115], a[80:83], v[48:63]
    buffer_load_dwordx2 v[202:203], v222, s[68:71], s83 offen sc1
    s_add_u32 s83, s83, 82944
    buffer_load_dwordx2 v[204:205], v222, s[68:71], s83 offen sc1
    s_add_u32 s83, s83, 82944
    buffer_load_dwordx2 v[206:207], v222, s[68:71], s83 offen sc1
    v_mfma_f32_32x32x16_bf16 v[64:79], v[116:119], a[80:83], v[64:79]
    s_mul_i32 s73, s3, 10240
    s_add_u32 s73, s73, 81920
    ds_read_b64_tr_b16 v[178:179], v237 offset:51712
    s_waitcnt lgkmcnt(6)
    ds_write_addtid_b32 v80 offset:0
    ds_write_addtid_b32 v80 offset:8316
    v_alignbit_b32 v92, v81, v80, 16
    v_lshl_add_u32 v235, v234, 3, s73
    v_mfma_f32_32x32x16_bf16 v[96:111], v[120:123], a[80:83], v[96:111]
    s_waitcnt vmcnt(23)
    ds_write_addtid_b32 v92 offset:4160
    ds_write_addtid_b32 v92 offset:12476
    s_waitcnt lgkmcnt(9)
    ds_write_addtid_b32 v82 offset:256
    ds_write_addtid_b32 v82 offset:8572
    v_alignbit_b32 v93, v83, v82, 16
    v_lshl_add_u32 v215, v233, 5, v235
    v_mfma_f32_32x32x16_bf16 v[48:63], v[124:127], a[84:87], v[48:63]
    ds_read2_b32 v[80:81], v225 offset0:128 offset1:129
    ds_write_addtid_b32 v93 offset:4416
    ds_write_addtid_b32 v93 offset:12732
    v_and_b32 v233, 4, v0
    v_lshlrev_b32 v233, 2, v233
    v_mfma_f32_32x32x16_bf16 v[64:79], v[128:131], a[84:87], v[64:79]
    ds_read_b64_tr_b16 v[180:181], v238 offset:25600
    ds_read_b64_tr_b16 v[182:183], v238 offset:25856
    s_waitcnt lgkmcnt(14)
    ds_write_addtid_b32 v84 offset:512
    ds_write_addtid_b32 v84 offset:8828
    v_alignbit_b32 v94, v85, v84, 16
    v_xor_b32 v215, v215, v233
    v_mfma_f32_32x32x16_bf16 v[96:111], v[132:135], a[84:87], v[96:111]
    s_waitcnt vmcnt(22)
    ds_read2_b32 v[82:83], v225 offset0:192 offset1:193
    ds_write_addtid_b32 v94 offset:4672
    ds_write_addtid_b32 v94 offset:12988
    v_and_b32_e64 v233, 8, v0
    v_mfma_f32_32x32x16_bf16 v[48:63], v[136:139], a[88:91], v[48:63]
    ds_read_b64_tr_b16 v[184:185], v236 offset:53248
    ds_write_addtid_b32 v86 offset:768
    ds_write_addtid_b32 v86 offset:9084
    v_alignbit_b32 v95, v87, v86, 16
    v_lshlrev_b32_e64 v233, 1, v233
    v_xor_b32 v233, v233, v1
    v_mfma_f32_32x32x16_bf16 v[64:79], v[140:143], a[88:91], v[64:79]
    ds_read2_b32 v[84:85], v226 offset0:0 offset1:1
    buffer_load_dwordx4 a[148:151], v1, s[68:71], s94 offen offset:1024 sc1
    ds_write_addtid_b32 v95 offset:4928
    ds_write_addtid_b32 v95 offset:13244
    v_add_u32 v216, s73, v233
    v_mfma_f32_32x32x16_bf16 v[96:111], v[144:147], a[88:91], v[96:111]
    s_waitcnt vmcnt(22)
    s_add_u32 s73, s3, 1
    ds_read_b64_tr_b16 v[186:187], v236 offset:53760
    ds_read_b64_tr_b16 v[188:189], v236 offset:55296
    s_waitcnt lgkmcnt(14)
    ds_write_addtid_b32 v88 offset:21280
    ds_write_addtid_b32 v88 offset:29596
    v_alignbit_b32 v92, v89, v88, 16
    v_mfma_f32_32x32x16_bf16 v[48:63], v[148:151], a[92:95], v[48:63]
    s_and_b32 s73, s73, 3
    ds_read_b64_tr_b16 v[190:191], v236 offset:55808
    ds_read_b64_tr_b16 v[112:113], v236 offset:57344
    buffer_load_dwordx4 a[152:155], v1, s[68:71], s94 offen offset:2048 sc1
    ds_write_addtid_b32 v92 offset:25440
    ds_write_addtid_b32 v92 offset:33756
    v_mfma_f32_32x32x16_bf16 v[64:79], v[152:155], a[92:95], v[64:79]
    s_mul_i32 s73, s73, 10240
    s_add_u32 s73, s73, 81920
    ds_read2_b32 v[86:87], v226 offset0:64 offset1:65
    ds_write_addtid_b32 v90 offset:21536
    ds_write_addtid_b32 v90 offset:29852
    v_alignbit_b32 v93, v91, v90, 16
    v_mfma_f32_32x32x16_bf16 v[96:111], v[156:159], a[92:95], v[96:111]
    s_waitcnt vmcnt(22)
    ds_read_b64_tr_b16 v[114:115], v236 offset:57856
    ds_read_b64_tr_b16 v[116:117], v236 offset:59392
    buffer_load_dwordx4 a[156:159], v1, s[68:71], s94 offen offset:3072 sc1
    ds_write_addtid_b32 v93 offset:25696
    ds_write_addtid_b32 v93 offset:34012
    v_mfma_f32_32x32x16_bf16 v[48:63], v[160:163], a[96:99], v[48:63]
    s_nop 0
    ds_read_b64_tr_b16 v[118:119], v236 offset:59904
    ds_read_b64_tr_b16 v[120:121], v236 offset:61440
    ds_write_addtid_b32 v80 offset:21792
    ds_write_addtid_b32 v80 offset:30108
    v_alignbit_b32 v94, v81, v80, 16
    v_lshl_add_u32 v217, v0, 2, s73
    v_mfma_f32_32x32x16_bf16 v[64:79], v[164:167], a[96:99], v[64:79]
    ds_read2_b32 v[88:89], v226 offset0:128 offset1:129
    buffer_load_dwordx4 a[160:163], v1, s[68:71], s85 offen offset:0 sc1
    ds_write_addtid_b32 v94 offset:25952
    ds_write_addtid_b32 v94 offset:34268
    v_lshrrev_b32_e64 v233, 3, v0
    v_mfma_f32_32x32x16_bf16 v[96:111], v[168:171], a[96:99], v[96:111]
    s_waitcnt vmcnt(23)
    ds_read_b64_tr_b16 v[122:123], v236 offset:61952
    ds_read_b64_tr_b16 v[124:125], v236 offset:63488
    s_waitcnt lgkmcnt(14)
    ds_write_addtid_b32 v82 offset:22048
    ds_write_addtid_b32 v82 offset:30364
    v_alignbit_b32 v95, v83, v82, 16
    v_and_b32_e64 v234, 7, v0
    v_mfma_f32_32x32x16_bf16 v[48:63], v[172:175], a[100:103], v[48:63]
    ds_read_b64_tr_b16 v[126:127], v236 offset:64000
    buffer_load_dwordx4 a[164:167], v1, s[68:71], s85 offen offset:1024 sc1
    ds_write_addtid_b32 v95 offset:26208
    ds_write_addtid_b32 v95 offset:34524
    v_add_u32 v236, 0x10000, v236
    v_mfma_f32_32x32x16_bf16 v[64:79], v[176:179], a[100:103], v[64:79]
    ds_read2_b32 v[90:91], v226 offset0:192 offset1:193
    ds_write_addtid_b32 v84 offset:42560
    ds_write_addtid_b32 v84 offset:50876
    v_alignbit_b32 v92, v85, v84, 16
    v_mul_u32_u24 v44, 4224, v233
    v_lshl_add_u32 v44, v234, 4, v44
    v_mfma_f32_32x32x16_bf16 v[96:111], v[180:183], a[100:103], v[96:111]
    s_waitcnt vmcnt(23)
    ds_read_b64_tr_b16 v[128:129], v236 offset:0
    ds_read_b64_tr_b16 v[130:131], v236 offset:512
    buffer_load_dwordx4 a[168:171], v1, s[68:71], s85 offen offset:2048 sc1
    ds_write_addtid_b32 v92 offset:46720
    ds_write_addtid_b32 v92 offset:55036
    v_mfma_f32_32x32x16_bf16 v[48:63], v[184:187], a[104:107], v[48:63]
    s_waitcnt vmcnt(23)
    ds_read_b64_tr_b16 v[132:133], v236 offset:2048
    ds_read_b64_tr_b16 v[134:135], v236 offset:2560
    ds_write_addtid_b32 v86 offset:42816
    ds_write_addtid_b32 v86 offset:51132
    v_alignbit_b32 v93, v87, v86, 16
    v_lshrrev_b32 v234, 1, v234
    v_mfma_f32_32x32x16_bf16 v[48:63], v[188:191], a[108:111], v[48:63]
    s_waitcnt vmcnt(22) lgkmcnt(14)
    ds_read_b64_tr_b16 v[136:137], v236 offset:4096
    ds_read_b64_tr_b16 v[138:139], v236 offset:4608
    buffer_load_dwordx4 a[172:175], v1, s[68:71], s85 offen offset:3072 sc1
    s_add_u32 s85, s85, 4096
    ds_write_addtid_b32 v93 offset:46976
    v_mfma_f32_32x32x16_bf16 v[48:63], v[112:115], a[112:115], v[48:63]
    s_waitcnt vmcnt(22)
    ds_read_b64_tr_b16 v[140:141], v236 offset:6144
    ds_read_b64_tr_b16 v[142:143], v236 offset:6656
    ds_write_addtid_b32 v93 offset:55292
    ds_write_addtid_b32 v88 offset:43072
    v_mul_u32_u24 v214, 2592, v234
    v_lshl_add_u32 v214, v233, 5, v214
    v_mfma_f32_32x32x16_bf16 v[48:63], v[116:119], a[116:119], v[48:63]
    s_waitcnt vmcnt(21)
    ds_read_b64_tr_b16 v[144:145], v236 offset:8192
    ds_read_b64_tr_b16 v[146:147], v236 offset:8704
    buffer_load_dwordx4 a[176:179], v1, s[68:71], s85 offen offset:0 sc1
    ds_write_addtid_b32 v88 offset:51388
    v_alignbit_b32 v94, v89, v88, 16
    v_mfma_f32_32x32x16_bf16 v[48:63], v[120:123], a[120:123], v[48:63]
    s_waitcnt vmcnt(20) lgkmcnt(14)
    s_mul_i32 s73, s3, 640
    s_add_u32 s73, s73, 135168
    ds_read_b64_tr_b16 v[148:149], v236 offset:10240
    ds_write_addtid_b32 v94 offset:47232
    ds_write_addtid_b32 v94 offset:55548
    ds_write_addtid_b32 v90 offset:43328
    v_mfma_f32_32x32x16_bf16 v[48:63], v[124:127], a[124:127], v[48:63]
    s_waitcnt vmcnt(18)
    ds_read_b64_tr_b16 v[150:151], v236 offset:10752
    buffer_load_dwordx4 a[180:183], v1, s[68:71], s85 offen offset:1024 sc1
    ds_write_addtid_b32 v90 offset:51644
    v_and_b32 v234, 1, v0
    v_alignbit_b32 v95, v91, v90, 16
    v_mfma_f32_32x32x16_bf16 v[48:63], v[128:131], a[128:131], v[48:63]
    s_waitcnt vmcnt(18) lgkmcnt(14)
    ds_read_b64_tr_b16 v[152:153], v236 offset:12288
    ds_read_b64_tr_b16 v[154:155], v236 offset:12800
    ds_write_addtid_b32 v95 offset:47488
    ds_write_addtid_b32 v95 offset:55804
    v_lshl_add_u32 v234, v234, 4, s73
    v_add_u32_e64 v214, v214, v234
    v_mfma_f32_32x32x16_bf16 v[48:63], v[132:135], a[132:135], v[48:63]
    s_waitcnt vmcnt(16)
    ds_read_b64_tr_b16 v[156:157], v236 offset:14336
    ds_read_b64_tr_b16 v[158:159], v236 offset:14848
    buffer_load_dwordx4 a[184:187], v1, s[68:71], s85 offen offset:2048 sc1
    ds_write_b32 v227, v26
    v_mfma_f32_32x32x16_bf16 v[48:63], v[136:139], a[136:139], v[48:63]
    s_waitcnt vmcnt(15) lgkmcnt(14)
    s_mul_i32 s73, s3, 2592
    ds_write_b64 v228, v[26:27]
    v_alignbit_b32 v192, v193, v192, s96
    v_lshrrev_b32 v193, s96, v193
    v_mfma_f32_32x32x16_bf16 v[48:63], v[140:143], a[140:143], v[48:63]
    s_waitcnt vmcnt(13)
    ds_read_b64_tr_b16 v[160:161], v237 offset:53248
    ds_read_b64_tr_b16 v[162:163], v237 offset:53760
    buffer_load_dwordx4 a[188:191], v1, s[68:71], s85 offen offset:3072 sc1
    s_add_u32 s85, s85, 4096
    v_alignbit_b32 v194, v195, v194, s96
    v_mfma_f32_32x32x16_bf16 v[48:63], v[144:147], a[144:147], v[48:63]
    s_waitcnt vmcnt(10) lgkmcnt(11)
    s_add_u32 s73, s73, 135168
    ds_read_b64_tr_b16 v[164:165], v237 offset:55296
    ds_read_b64_tr_b16 v[166:167], v237 offset:55808
    v_lshrrev_b32 v195, s96, v195
    v_alignbit_b32 v196, v197, v196, s96
    v_lshl_add_u32 v220, v0, 3, s73
    v_mfma_f32_32x32x16_bf16 v[48:63], v[148:151], a[148:151], v[48:63]
    s_waitcnt vmcnt(9) lgkmcnt(10)
    ds_read_b64_tr_b16 v[168:169], v237 offset:57344
    ds_read_b64_tr_b16 v[170:171], v237 offset:57856
    buffer_load_dwordx4 a[192:195], v1, s[68:71], s85 offen offset:0 sc1
    v_lshrrev_b32 v197, s96, v197
    v_alignbit_b32 v198, v199, v198, s96
    v_mfma_f32_32x32x16_bf16 v[48:63], v[152:155], a[152:155], v[48:63]
    s_waitcnt vmcnt(9) lgkmcnt(8)
    ds_read_b64_tr_b16 v[172:173], v237 offset:59392
    v_lshrrev_b32 v233, 5, v0
    v_lshl_add_u32 v221, v233, 30, v1
    v_lshl_add_u32 v46, v233, 30, v44
    v_lshl_add_u32 v47, v233, 14, v214
    v_lshrrev_b32 v199, s96, v199
    v_mfma_f32_32x32x16_bf16 v[48:63], v[156:159], a[156:159], v[48:63]
    s_waitcnt lgkmcnt(5)
    ds_read_b64_tr_b16 v[174:175], v237 offset:59904
    ds_read_b64_tr_b16 v[176:177], v237 offset:61440
    buffer_load_dwordx4 a[196:199], v1, s[68:71], s85 offen offset:1024 sc1
    ds_write_b16 v223, v192 offset:0
    v_mfma_f32_32x32x16_bf16 v[64:79], v[160:163], a[104:107], v[64:79]
    s_waitcnt lgkmcnt(6)
    ds_read_b64_tr_b16 v[178:179], v237 offset:61952
    ds_read_b64_tr_b16 v[180:181], v237 offset:63488
    ds_write_b16_d16_hi v223, v192 offset:21280
    v_mfma_f32_32x32x16_bf16 v[64:79], v[164:167], a[108:111], v[64:79]
    s_waitcnt lgkmcnt(7)
    ds_read_b64_tr_b16 v[182:183], v237 offset:64000
    buffer_load_dwordx4 a[200:203], v1, s[68:71], s85 offen offset:2048 sc1
    ds_write_b16 v223, v193 offset:42560
    v_add_u32 v237, 0x10000, v237
    v_mfma_f32_32x32x16_bf16 v[64:79], v[168:171], a[112:115], v[64:79]
    s_waitcnt lgkmcnt(7)
    ds_read_b64_tr_b16 v[184:185], v237 offset:0
    ds_read_b64_tr_b16 v[186:187], v237 offset:512
    ds_write_b16 v223, v194 offset:128
    v_mul_f32 v2, v48, v48
    v_mul_f32_e64 v3, v49, v49
    v_mfma_f32_32x32x16_bf16 v[64:79], v[172:175], a[116:119], v[64:79]
    s_waitcnt lgkmcnt(7)
    ds_read_b64_tr_b16 v[188:189], v237 offset:2048
    buffer_load_dwordx4 a[204:207], v1, s[68:71], s85 offen offset:3072 sc1
    s_add_u32 s85, s85, 40960
    ds_write_b16_d16_hi v223, v194 offset:21408
    v_mfma_f32_32x32x16_bf16 v[64:79], v[176:179], a[120:123], v[64:79]
    s_waitcnt lgkmcnt(6)
    ds_read_b64_tr_b16 v[190:191], v237 offset:2560
    ds_read_b64_tr_b16 v[112:113], v237 offset:4096
    ds_write_b16 v223, v195 offset:42688
    v_fma_f32 v2, v2, v9, v8
    v_fma_f32 v3, v3, v9, v8
    v_mfma_f32_32x32x16_bf16 v[64:79], v[180:183], a[124:127], v[64:79]
    s_waitcnt lgkmcnt(6)
    ds_read_b64_tr_b16 v[114:115], v237 offset:4608
    ds_read_b64_tr_b16 v[116:117], v237 offset:6144
    buffer_load_dwordx4 a[208:211], v1, s[68:71], s85 offen offset:0 sc1
    ds_write_b16 v223, v196 offset:256
    v_mfma_f32_32x32x16_bf16 v[64:79], v[184:187], a[128:131], v[64:79]
    s_waitcnt lgkmcnt(5)
    ds_read_b64_tr_b16 v[118:119], v237 offset:6656
    ds_read_b64_tr_b16 v[120:121], v237 offset:8192
    ds_write_b16_d16_hi v223, v196 offset:21536
    v_mul_f32_e64 v2, v2, v48
    v_mul_f32 v3, v3, v49
    v_mfma_f32_32x32x16_bf16 v[64:79], v[188:191], a[132:135], v[64:79]
    s_waitcnt lgkmcnt(5)
    ds_read_b64_tr_b16 v[122:123], v237 offset:8704
    ds_read_b64_tr_b16 v[124:125], v237 offset:10240
    buffer_load_dwordx4 a[212:215], v1, s[68:71], s85 offen offset:1024 sc1
    ds_write_b16 v223, v197 offset:42816
    v_mfma_f32_32x32x16_bf16 v[64:79], v[112:115], a[136:139], v[64:79]
    s_waitcnt lgkmcnt(5)
    ds_read_b64_tr_b16 v[126:127], v237 offset:10752
    ds_read_b64_tr_b16 v[128:129], v237 offset:12288
    ds_write_b16 v223, v198 offset:384
    v_exp_f32 v2, v2
    v_mfma_f32_32x32x16_bf16 v[64:79], v[116:119], a[140:143], v[64:79]
    s_waitcnt lgkmcnt(5)
    ds_read_b64_tr_b16 v[130:131], v237 offset:12800
    ds_read_b64_tr_b16 v[132:133], v237 offset:14336
    buffer_load_dwordx4 a[216:219], v1, s[68:71], s85 offen offset:2048 sc1
    ds_write_b16_d16_hi v223, v198 offset:21664
    v_mfma_f32_32x32x16_bf16 v[64:79], v[120:123], a[144:147], v[64:79]
    s_waitcnt lgkmcnt(5)
    ds_read_b64_tr_b16 v[134:135], v237 offset:14848
    ds_read_b64_tr_b16 v[136:137], v238 offset:26624
    ds_write_b16 v223, v199 offset:42944
    v_exp_f32 v3, v3
    v_mfma_f32_32x32x16_bf16 v[64:79], v[124:127], a[148:151], v[64:79]
    s_waitcnt lgkmcnt(5)
    ds_read_b64_tr_b16 v[138:139], v238 offset:26880
    buffer_load_dwordx4 a[220:223], v1, s[68:71], s85 offen offset:3072 sc1
    s_add_u32 s85, s85, 4096
    v_alignbit_b32 v200, v201, v200, s96
    v_fma_f32 v2, v2, v30, v30
    v_mfma_f32_32x32x16_bf16 v[64:79], v[128:131], a[152:155], v[64:79]
    s_waitcnt lgkmcnt(3)
    ds_read_b64_tr_b16 v[140:141], v238 offset:27648
    ds_read_b64_tr_b16 v[142:143], v238 offset:27904
    v_lshrrev_b32 v201, s96, v201
    v_fma_f32 v3, v3, v30, v30
    v_alignbit_b32 v202, v203, v202, s96
    v_lshrrev_b32 v203, s96, v203
    v_mfma_f32_32x32x16_bf16 v[64:79], v[132:135], a[156:159], v[64:79]
    s_waitcnt lgkmcnt(2)
    ds_read_b64_tr_b16 v[144:145], v238 offset:28672
    ds_read_b64_tr_b16 v[146:147], v238 offset:28928
    buffer_load_dwordx4 a[224:227], v1, s[68:71], s85 offen offset:0 sc1
    v_rcp_f32 v2, v2
    v_mfma_f32_32x32x16_bf16 v[96:111], v[136:139], a[104:107], v[96:111]
    s_waitcnt lgkmcnt(2)
    ds_read_b64_tr_b16 v[148:149], v238 offset:29696
    ds_read_b64_tr_b16 v[150:151], v238 offset:29952
    v_alignbit_b32 v204, v205, v204, s96
    v_lshrrev_b32 v205, s96, v205
    v_alignbit_b32 v206, v207, v206, s96
    v_lshrrev_b32 v207, s96, v207
    v_mfma_f32_32x32x16_bf16 v[96:111], v[140:143], a[108:111], v[96:111]
    s_waitcnt lgkmcnt(2)
    ds_read_b64_tr_b16 v[152:153], v238 offset:30720
    ds_read_b64_tr_b16 v[154:155], v238 offset:30976
    buffer_load_dwordx4 a[228:231], v1, s[68:71], s85 offen offset:1024 sc1
    v_rcp_f32 v3, v3
    v_mfma_f32_32x32x16_bf16 v[96:111], v[144:147], a[112:115], v[96:111]
    s_waitcnt lgkmcnt(2)
    ds_read_b64_tr_b16 v[156:157], v238 offset:31744
    ds_read_b64_tr_b16 v[158:159], v238 offset:32000
    ds_write_b16 v223, v200 offset:512
    v_mul_f32 v2, v2, v48
    v_mul_f32_e64 v3, v3, v49
    v_mfma_f32_32x32x16_bf16 v[96:111], v[148:151], a[116:119], v[96:111]
    s_waitcnt lgkmcnt(3)
    ds_read_b64_tr_b16 v[160:161], v238 offset:32768
    ds_read_b64_tr_b16 v[162:163], v238 offset:33024
    buffer_load_dwordx4 a[232:235], v1, s[68:71], s85 offen offset:2048 sc1
    ds_write_b16_d16_hi v223, v200 offset:21792
    v_mfma_f32_32x32x16_bf16 v[96:111], v[152:155], a[120:123], v[96:111]
    s_waitcnt lgkmcnt(4)
    ds_read_b64_tr_b16 v[164:165], v238 offset:33792
    ds_read_b64_tr_b16 v[166:167], v238 offset:34048
    ds_write_b16 v223, v201 offset:43072
    v_cvt_pk_bf16_f32 v10, v2, v3
    v_mul_f32 v4, v50, v50
    v_mfma_f32_32x32x16_bf16 v[96:111], v[156:159], a[124:127], v[96:111]
    s_waitcnt lgkmcnt(4)
    ds_read_b64_tr_b16 v[168:169], v238 offset:34816
    ds_read_b64_tr_b16 v[170:171], v238 offset:35072
    ds_write_b16 v223, v202 offset:640
    v_mul_f32_e64 v5, v51, v51
    v_fma_f32 v4, v4, v9, v8
    v_mfma_f32_32x32x16_bf16 v[96:111], v[160:163], a[128:131], v[96:111]
    s_waitcnt lgkmcnt(4)
    ds_read_b64_tr_b16 v[172:173], v238 offset:35840
    ds_read_b64_tr_b16 v[174:175], v238 offset:36096
    buffer_load_dwordx4 a[236:239], v1, s[68:71], s85 offen offset:3072 sc1
    ds_write_b16_d16_hi v223, v202 offset:21920
    v_mfma_f32_32x32x16_bf16 v[96:111], v[164:167], a[132:135], v[96:111]
    s_waitcnt lgkmcnt(4)
    ds_read_b64_tr_b16 v[176:177], v238 offset:36864
    ds_read_b64_tr_b16 v[178:179], v238 offset:37120
    ds_write_b16 v223, v203 offset:43200
    v_fma_f32 v5, v5, v9, v8
    v_mul_f32 v4, v4, v50
    v_mfma_f32_32x32x16_bf16 v[96:111], v[168:171], a[136:139], v[96:111]
    s_waitcnt lgkmcnt(4)
    ds_read_b64_tr_b16 v[180:181], v238 offset:37888
    ds_read_b64_tr_b16 v[182:183], v238 offset:38144
    ds_write_b16 v223, v204 offset:768
    ds_write_b16_d16_hi v223, v204 offset:22048
    ds_write_b16 v223, v205 offset:43328
    ds_write_b16 v223, v206 offset:896
    ds_write_b16_d16_hi v223, v206 offset:22176
    ds_write_b16 v223, v207 offset:43456
    v_mfma_f32_32x32x16_bf16 v[96:111], v[172:175], a[140:143], v[96:111]
    s_waitcnt lgkmcnt(9)
    s_add_u32 s85, s85, 4096
    ds_read_b64_tr_b16 v[184:185], v238 offset:38912
    ds_read_b64_tr_b16 v[186:187], v238 offset:39168
    v_mul_f32 v5, v5, v51
    v_exp_f32 v4, v4
    v_mfma_f32_32x32x16_bf16 v[96:111], v[176:179], a[144:147], v[96:111]
    s_waitcnt lgkmcnt(8)
    ds_read_b64_tr_b16 v[188:189], v238 offset:39936
    ds_read_b64_tr_b16 v[190:191], v238 offset:40192
    buffer_load_dwordx4 a[0:3], v1, s[68:71], s85 offen offset:0 sc1
    v_exp_f32 v5, v5
    v_mfma_f32_32x32x16_bf16 v[96:111], v[180:183], a[148:151], v[96:111]
    s_waitcnt lgkmcnt(2)
    v_fma_f32 v4, v4, v30, v30
    v_fma_f32 v5, v5, v30, v30
    v_rcp_f32 v4, v4
    v_rcp_f32 v5, v5
    v_mfma_f32_32x32x16_bf16 v[96:111], v[184:187], a[152:155], v[96:111]
    s_waitcnt lgkmcnt(0)
    buffer_load_dwordx4 a[4:7], v1, s[68:71], s85 offen offset:1024 sc1
    v_mul_f32 v4, v4, v50
    v_mul_f32_e64 v5, v5, v51
    v_cvt_pk_bf16_f32 v11, v4, v5
    v_mfma_f32_32x32x16_bf16 v[96:111], v[188:191], a[156:159], v[96:111]
    buffer_load_dwordx4 a[8:11], v1, s[68:71], s85 offen offset:2048 sc1
    buffer_load_dwordx4 a[12:15], v1, s[68:71], s85 offen offset:3072 sc1
    v_pk_mul_f32 v[2:3], v[52:53], v[52:53]
    v_pk_mul_f32 v[4:5], v[54:55], v[54:55]
    v_pk_fma_f32 v[2:3], v[2:3], v[8:9], v[8:9] op_sel:[0,1,0] op_sel_hi:[1,1,0]
    v_pk_fma_f32 v[4:5], v[4:5], v[8:9], v[8:9] op_sel:[0,1,0] op_sel_hi:[1,1,0]
    v_pk_mul_f32 v[2:3], v[2:3], v[52:53]
    v_pk_mul_f32 v[4:5], v[4:5], v[54:55]
    v_exp_f32 v2, v2
    v_exp_f32 v3, v3
    v_exp_f32 v4, v4
    v_exp_f32 v5, v5
    v_pk_fma_f32 v[2:3], v[2:3], v[30:31], v[30:31] op_sel_hi:[1,0,0]
    v_pk_fma_f32 v[4:5], v[4:5], v[30:31], v[30:31] op_sel_hi:[1,0,0]
    v_rcp_f32 v2, v2
    v_rcp_f32 v3, v3
    v_rcp_f32 v4, v4
    v_rcp_f32 v5, v5
    v_pk_mul_f32 v[2:3], v[2:3], v[52:53]
    v_pk_mul_f32 v[4:5], v[4:5], v[54:55]
    v_cvt_pk_bf16_f32 v12, v2, v3
    v_cvt_pk_bf16_f32 v13, v4, v5
    buffer_store_dwordx4 v[10:13], v239, s[68:71], s92 offen offset:0 sc1
    v_pk_mul_f32 v[2:3], v[56:57], v[56:57]
    v_pk_mul_f32 v[4:5], v[58:59], v[58:59]
    v_pk_fma_f32 v[2:3], v[2:3], v[8:9], v[8:9] op_sel:[0,1,0] op_sel_hi:[1,1,0]
    v_pk_fma_f32 v[4:5], v[4:5], v[8:9], v[8:9] op_sel:[0,1,0] op_sel_hi:[1,1,0]
    v_pk_mul_f32 v[2:3], v[2:3], v[56:57]
    v_pk_mul_f32 v[4:5], v[4:5], v[58:59]
    v_exp_f32 v2, v2
    v_exp_f32 v3, v3
    v_exp_f32 v4, v4
    v_exp_f32 v5, v5
    v_pk_fma_f32 v[2:3], v[2:3], v[30:31], v[30:31] op_sel_hi:[1,0,0]
    v_pk_fma_f32 v[4:5], v[4:5], v[30:31], v[30:31] op_sel_hi:[1,0,0]
    v_rcp_f32 v2, v2
    v_rcp_f32 v3, v3
    v_rcp_f32 v4, v4
    v_rcp_f32 v5, v5
    v_pk_mul_f32 v[2:3], v[2:3], v[56:57]
    v_pk_mul_f32 v[4:5], v[4:5], v[58:59]
    v_cvt_pk_bf16_f32 v14, v2, v3
    v_cvt_pk_bf16_f32 v15, v4, v5
    s_add_u32 s85, s85, 40960
    buffer_load_dwordx4 a[16:19], v1, s[68:71], s85 offen offset:0 sc1
    v_pk_mul_f32 v[2:3], v[60:61], v[60:61]
    v_pk_mul_f32 v[4:5], v[62:63], v[62:63]
    v_pk_fma_f32 v[2:3], v[2:3], v[8:9], v[8:9] op_sel:[0,1,0] op_sel_hi:[1,1,0]
    v_pk_fma_f32 v[4:5], v[4:5], v[8:9], v[8:9] op_sel:[0,1,0] op_sel_hi:[1,1,0]
    v_pk_mul_f32 v[2:3], v[2:3], v[60:61]
    v_pk_mul_f32 v[4:5], v[4:5], v[62:63]
    v_exp_f32 v2, v2
    v_exp_f32 v3, v3
    v_exp_f32 v4, v4
    v_exp_f32 v5, v5
    v_pk_fma_f32 v[2:3], v[2:3], v[30:31], v[30:31] op_sel_hi:[1,0,0]
    v_pk_fma_f32 v[4:5], v[4:5], v[30:31], v[30:31] op_sel_hi:[1,0,0]
    v_rcp_f32 v2, v2
    v_rcp_f32 v3, v3
    v_rcp_f32 v4, v4
    v_rcp_f32 v5, v5
    v_pk_mul_f32 v[2:3], v[2:3], v[60:61]
    v_pk_mul_f32 v[4:5], v[4:5], v[62:63]
    v_cvt_pk_bf16_f32 v16, v2, v3
    v_cvt_pk_bf16_f32 v17, v4, v5
    buffer_store_dwordx4 v[14:17], v239, s[68:71], s92 offen offset:512 sc1
    v_pk_mul_f32 v[2:3], v[64:65], v[64:65]
    v_pk_mul_f32 v[4:5], v[66:67], v[66:67]
    v_pk_fma_f32 v[2:3], v[2:3], v[8:9], v[8:9] op_sel:[0,1,0] op_sel_hi:[1,1,0]
    v_pk_fma_f32 v[4:5], v[4:5], v[8:9], v[8:9] op_sel:[0,1,0] op_sel_hi:[1,1,0]
    v_pk_mul_f32 v[2:3], v[2:3], v[64:65]
    v_pk_mul_f32 v[4:5], v[4:5], v[66:67]
    v_exp_f32 v2, v2
    v_exp_f32 v3, v3
    v_exp_f32 v4, v4
    v_exp_f32 v5, v5
    v_pk_fma_f32 v[2:3], v[2:3], v[30:31], v[30:31] op_sel_hi:[1,0,0]
    v_pk_fma_f32 v[4:5], v[4:5], v[30:31], v[30:31] op_sel_hi:[1,0,0]
    v_rcp_f32 v2, v2
    v_rcp_f32 v3, v3
    v_rcp_f32 v4, v4
    v_rcp_f32 v5, v5
    v_pk_mul_f32 v[2:3], v[2:3], v[64:65]
    v_pk_mul_f32 v[4:5], v[4:5], v[66:67]
    v_cvt_pk_bf16_f32 v18, v2, v3
    v_cvt_pk_bf16_f32 v19, v4, v5
    buffer_load_dwordx4 a[20:23], v1, s[68:71], s85 offen offset:1024 sc1
    v_pk_mul_f32 v[2:3], v[68:69], v[68:69]
    v_pk_mul_f32 v[4:5], v[70:71], v[70:71]
    v_pk_fma_f32 v[2:3], v[2:3], v[8:9], v[8:9] op_sel:[0,1,0] op_sel_hi:[1,1,0]
    v_pk_fma_f32 v[4:5], v[4:5], v[8:9], v[8:9] op_sel:[0,1,0] op_sel_hi:[1,1,0]
    v_pk_mul_f32 v[2:3], v[2:3], v[68:69]
    v_pk_mul_f32 v[4:5], v[4:5], v[70:71]
    v_exp_f32 v2, v2
    v_exp_f32 v3, v3
    v_exp_f32 v4, v4
    v_exp_f32 v5, v5
    v_pk_fma_f32 v[2:3], v[2:3], v[30:31], v[30:31] op_sel_hi:[1,0,0]
    v_pk_fma_f32 v[4:5], v[4:5], v[30:31], v[30:31] op_sel_hi:[1,0,0]
    v_rcp_f32 v2, v2
    v_rcp_f32 v3, v3
    v_rcp_f32 v4, v4
    v_rcp_f32 v5, v5
    v_pk_mul_f32 v[2:3], v[2:3], v[68:69]
    v_pk_mul_f32 v[4:5], v[4:5], v[70:71]
    v_cvt_pk_bf16_f32 v20, v2, v3
    v_cvt_pk_bf16_f32 v21, v4, v5
    buffer_store_dwordx4 v[18:21], v239, s[68:71], s92 offen offset:1024 sc1
    v_pk_mul_f32 v[2:3], v[72:73], v[72:73]
    v_pk_mul_f32 v[4:5], v[74:75], v[74:75]
    v_pk_fma_f32 v[2:3], v[2:3], v[8:9], v[8:9] op_sel:[0,1,0] op_sel_hi:[1,1,0]
    v_pk_fma_f32 v[4:5], v[4:5], v[8:9], v[8:9] op_sel:[0,1,0] op_sel_hi:[1,1,0]
    v_pk_mul_f32 v[2:3], v[2:3], v[72:73]
    v_pk_mul_f32 v[4:5], v[4:5], v[74:75]
    v_exp_f32 v2, v2
    v_exp_f32 v3, v3
    v_exp_f32 v4, v4
    v_exp_f32 v5, v5
    v_pk_fma_f32 v[2:3], v[2:3], v[30:31], v[30:31] op_sel_hi:[1,0,0]
    v_pk_fma_f32 v[4:5], v[4:5], v[30:31], v[30:31] op_sel_hi:[1,0,0]
    v_rcp_f32 v2, v2
    v_rcp_f32 v3, v3
    v_rcp_f32 v4, v4
    v_rcp_f32 v5, v5
    v_pk_mul_f32 v[2:3], v[2:3], v[72:73]
    v_pk_mul_f32 v[4:5], v[4:5], v[74:75]
    v_cvt_pk_bf16_f32 v22, v2, v3
    v_cvt_pk_bf16_f32 v23, v4, v5
    buffer_load_dwordx4 a[24:27], v1, s[68:71], s85 offen offset:2048 sc1
    v_pk_mul_f32 v[2:3], v[76:77], v[76:77]
    v_pk_mul_f32 v[4:5], v[78:79], v[78:79]
    v_pk_fma_f32 v[2:3], v[2:3], v[8:9], v[8:9] op_sel:[0,1,0] op_sel_hi:[1,1,0]
    v_pk_fma_f32 v[4:5], v[4:5], v[8:9], v[8:9] op_sel:[0,1,0] op_sel_hi:[1,1,0]
    v_pk_mul_f32 v[2:3], v[2:3], v[76:77]
    v_pk_mul_f32 v[4:5], v[4:5], v[78:79]
    v_exp_f32 v2, v2
    v_exp_f32 v3, v3
    v_exp_f32 v4, v4
    v_exp_f32 v5, v5
    v_pk_fma_f32 v[2:3], v[2:3], v[30:31], v[30:31] op_sel_hi:[1,0,0]
    v_pk_fma_f32 v[4:5], v[4:5], v[30:31], v[30:31] op_sel_hi:[1,0,0]
    v_rcp_f32 v2, v2
    v_rcp_f32 v3, v3
    v_rcp_f32 v4, v4
    v_rcp_f32 v5, v5
    v_pk_mul_f32 v[2:3], v[2:3], v[76:77]
    v_pk_mul_f32 v[4:5], v[4:5], v[78:79]
    v_cvt_pk_bf16_f32 v24, v2, v3
    v_cvt_pk_bf16_f32 v25, v4, v5
    buffer_store_dwordx4 v[22:25], v239, s[68:71], s92 offen offset:1536 sc1
    v_pk_mul_f32 v[2:3], v[96:97], v[96:97]
    v_pk_mul_f32 v[4:5], v[98:99], v[98:99]
    v_pk_fma_f32 v[2:3], v[2:3], v[8:9], v[8:9] op_sel:[0,1,0] op_sel_hi:[1,1,0]
    v_pk_fma_f32 v[4:5], v[4:5], v[8:9], v[8:9] op_sel:[0,1,0] op_sel_hi:[1,1,0]
    v_pk_mul_f32 v[2:3], v[2:3], v[96:97]
    v_pk_mul_f32 v[4:5], v[4:5], v[98:99]
    v_exp_f32 v2, v2
    v_exp_f32 v3, v3
    v_exp_f32 v4, v4
    v_exp_f32 v5, v5
    v_pk_fma_f32 v[2:3], v[2:3], v[30:31], v[30:31] op_sel_hi:[1,0,0]
    v_pk_fma_f32 v[4:5], v[4:5], v[30:31], v[30:31] op_sel_hi:[1,0,0]
    v_rcp_f32 v2, v2
    v_rcp_f32 v3, v3
    v_rcp_f32 v4, v4
    v_rcp_f32 v5, v5
    v_pk_mul_f32 v[2:3], v[2:3], v[96:97]
    v_pk_mul_f32 v[4:5], v[4:5], v[98:99]
    v_cvt_pk_bf16_f32 v80, v2, v3
    v_cvt_pk_bf16_f32 v81, v4, v5
    buffer_load_dwordx4 a[28:31], v1, s[68:71], s85 offen offset:3072 sc1
    v_pk_mul_f32 v[2:3], v[100:101], v[100:101]
    v_pk_mul_f32 v[4:5], v[102:103], v[102:103]
    v_pk_fma_f32 v[2:3], v[2:3], v[8:9], v[8:9] op_sel:[0,1,0] op_sel_hi:[1,1,0]
    v_pk_fma_f32 v[4:5], v[4:5], v[8:9], v[8:9] op_sel:[0,1,0] op_sel_hi:[1,1,0]
    v_pk_mul_f32 v[2:3], v[2:3], v[100:101]
    v_pk_mul_f32 v[4:5], v[4:5], v[102:103]
    v_exp_f32 v2, v2
    v_exp_f32 v3, v3
    v_exp_f32 v4, v4
    v_exp_f32 v5, v5
    v_pk_fma_f32 v[2:3], v[2:3], v[30:31], v[30:31] op_sel_hi:[1,0,0]
    v_pk_fma_f32 v[4:5], v[4:5], v[30:31], v[30:31] op_sel_hi:[1,0,0]
    v_rcp_f32 v2, v2
    v_rcp_f32 v3, v3
    v_rcp_f32 v4, v4
    v_rcp_f32 v5, v5
    v_pk_mul_f32 v[2:3], v[2:3], v[100:101]
    v_pk_mul_f32 v[4:5], v[4:5], v[102:103]
    v_cvt_pk_bf16_f32 v82, v2, v3
    v_cvt_pk_bf16_f32 v83, v4, v5
    buffer_store_dwordx4 v[80:83], v239, s[68:71], s93 offen offset:0 sc1
    s_waitcnt lgkmcnt(0)
    s_barrier
    s_cmp_eq_u32 s3, 3
    s_cbranch_scc1 L_cv3
    ds_read_b128 v[112:115], v213 offset:17120
    ds_read_b64 v[116:117], v212 offset:448
    ds_read_b64 v[118:119], v212 offset:456
    ds_read_b64 v[120:121], v212 offset:960
    ds_read_b64 v[122:123], v212 offset:968
    ds_read_b64 v[124:125], v212 offset:1472
    ds_read_b64 v[126:127], v212 offset:1480
    ds_read_b64 v[48:49], v212 offset:1984
    ds_read_b64 v[50:51], v212 offset:1992
    ds_read_b128 v[52:55], v213 offset:17632
    ds_read_b64 v[56:57], v212 offset:2496
    ds_read_b64 v[58:59], v212 offset:2504
    ds_read_b128 v[60:63], v213 offset:18144
    ds_read_b64 v[64:65], v212 offset:3008
    ds_read_b64 v[66:67], v212 offset:3016
    v_pk_mul_f32 v[2:3], v[104:105], v[104:105]
    v_pk_mul_f32 v[4:5], v[106:107], v[106:107]
    v_pk_fma_f32 v[2:3], v[2:3], v[8:9], v[8:9] op_sel:[0,1,0] op_sel_hi:[1,1,0]
    v_pk_fma_f32 v[4:5], v[4:5], v[8:9], v[8:9] op_sel:[0,1,0] op_sel_hi:[1,1,0]
    v_pk_mul_f32 v[2:3], v[2:3], v[104:105]
    v_pk_mul_f32 v[4:5], v[4:5], v[106:107]
    v_exp_f32 v2, v2
    v_exp_f32 v3, v3
    v_exp_f32 v4, v4
    v_exp_f32 v5, v5
    v_pk_fma_f32 v[2:3], v[2:3], v[30:31], v[30:31] op_sel_hi:[1,0,0]
    v_pk_fma_f32 v[4:5], v[4:5], v[30:31], v[30:31] op_sel_hi:[1,0,0]
    v_rcp_f32 v2, v2
    v_rcp_f32 v3, v3
    v_rcp_f32 v4, v4
    v_rcp_f32 v5, v5
    v_pk_mul_f32 v[2:3], v[2:3], v[104:105]
    v_pk_mul_f32 v[4:5], v[4:5], v[106:107]
    v_cvt_pk_bf16_f32 v84, v2, v3
    v_cvt_pk_bf16_f32 v85, v4, v5
    s_add_u32 s85, s85, 4096
    buffer_load_dwordx4 a[32:35], v1, s[68:71], s85 offen offset:0 sc1
    v_pk_mul_f32 v[2:3], v[108:109], v[108:109]
    v_pk_mul_f32 v[4:5], v[110:111], v[110:111]
    v_pk_fma_f32 v[2:3], v[2:3], v[8:9], v[8:9] op_sel:[0,1,0] op_sel_hi:[1,1,0]
    v_pk_fma_f32 v[4:5], v[4:5], v[8:9], v[8:9] op_sel:[0,1,0] op_sel_hi:[1,1,0]
    v_pk_mul_f32 v[2:3], v[2:3], v[108:109]
    v_pk_mul_f32 v[4:5], v[4:5], v[110:111]
    v_exp_f32 v2, v2
    v_exp_f32 v3, v3
    v_exp_f32 v4, v4
    v_exp_f32 v5, v5
    v_pk_fma_f32 v[2:3], v[2:3], v[30:31], v[30:31] op_sel_hi:[1,0,0]
    v_pk_fma_f32 v[4:5], v[4:5], v[30:31], v[30:31] op_sel_hi:[1,0,0]
    v_rcp_f32 v2, v2
    v_rcp_f32 v3, v3
    v_rcp_f32 v4, v4
    v_rcp_f32 v5, v5
    v_pk_mul_f32 v[2:3], v[2:3], v[108:109]
    v_pk_mul_f32 v[4:5], v[4:5], v[110:111]
    v_cvt_pk_bf16_f32 v86, v2, v3
    v_cvt_pk_bf16_f32 v87, v4, v5
    buffer_store_dwordx4 v[84:87], v239, s[68:71], s93 offen offset:512 sc1
    s_waitcnt lgkmcnt(12)
    v_mfma_f32_16x16x32_bf16 v[14:17], v[116:119], v[112:115], 0
    s_waitcnt lgkmcnt(10)
    ds_read_b128 v[68:71], v213 offset:18656
    v_mfma_f32_16x16x32_bf16 v[10:13], v[120:123], v[112:115], 0
    s_waitcnt lgkmcnt(9)
    s_lshl_b32 s81, s8, 4
    s_add_u32 s81, s81, s9
    v_mfma_f32_16x16x32_bf16 v[6:9], v[124:127], v[112:115], 0
    s_waitcnt lgkmcnt(7)
    ds_read_b64 v[72:73], v212 offset:3520
    ds_read_b64 v[74:75], v212 offset:3528
    v_mfma_f32_16x16x32_bf16 v[2:5], v[48:51], v[112:115], 0
    s_waitcnt lgkmcnt(8)
    s_lshl_b32 s81, s81, 2
    ds_read_b64 v[76:77], v212 offset:4032
    v_mfma_f32_16x16x32_bf16 v[14:17], v[120:123], v[52:55], v[14:17]
    buffer_load_dwordx4 a[36:39], v1, s[68:71], s85 offen offset:1024 sc1
    v_mfma_f32_16x16x32_bf16 v[10:13], v[124:127], v[52:55], v[10:13]
    s_add_u32 s81, s81, s3
    ds_read_b64 v[78:79], v212 offset:4040
    v_accvgpr_write_b32 a241, 0
    v_mfma_f32_16x16x32_bf16 v[6:9], v[48:51], v[52:55], v[6:9]
    s_waitcnt lgkmcnt(8)
    ds_read_b128 v[88:91], v213 offset:19168
    v_mfma_f32_16x16x32_bf16 v[2:5], v[56:59], v[52:55], v[2:5]
    s_waitcnt lgkmcnt(8)
    s_lshl_b32 s81, s81, 8
    v_accvgpr_write_b32 a243, 0
    v_mfma_f32_16x16x32_bf16 v[14:17], v[124:127], v[60:63], v[14:17]
    buffer_load_dwordx4 a[40:43], v1, s[68:71], s85 offen offset:2048 sc1
    v_mfma_f32_16x16x32_bf16 v[10:13], v[48:51], v[60:63], v[10:13]
    s_add_u32 s81, s81, 17825792
    ds_read_b128 v[92:95], v213 offset:19680
    v_mfma_f32_16x16x32_bf16 v[6:9], v[56:59], v[60:63], v[6:9]
    s_waitcnt lgkmcnt(6)
    ds_read_b128 v[96:99], v213 offset:20192
    v_mfma_f32_16x16x32_bf16 v[2:5], v[64:67], v[60:63], v[2:5]
    s_lshr_b32 s86, s12, 1
    ds_read_b128 v[100:103], v213 offset:20704
    v_accvgpr_write_b32 a245, 0
    v_mfma_f32_16x16x32_bf16 v[14:17], v[48:51], v[68:71], v[14:17]
    buffer_load_dwordx4 a[44:47], v1, s[68:71], s85 offen offset:3072 sc1
    v_mfma_f32_16x16x32_bf16 v[10:13], v[56:59], v[68:71], v[10:13]
    s_lshl_b32 s86, s86, 2
    s_add_u32 s85, s85, 4096
    ds_read_b128 v[104:107], v213 offset:17056
    v_mfma_f32_16x16x32_bf16 v[6:9], v[64:67], v[68:71], v[6:9]
    s_waitcnt lgkmcnt(6)
    ds_read_b64 v[108:109], v212 offset:384
    ds_read_b64 v[110:111], v212 offset:392
    v_mfma_f32_16x16x32_bf16 v[2:5], v[72:75], v[68:71], v[2:5]
    s_add_u32 s86, s86, s3
    ds_read_b64 v[80:81], v212 offset:896
    v_accvgpr_write_b32 a247, 0
    v_mfma_f32_16x16x32_bf16 v[18:21], v[72:75], v[112:115], 0
    s_waitcnt lgkmcnt(7)
    ds_read_b64 v[82:83], v212 offset:904
    ds_read_b64 v[84:85], v212 offset:1408
    v_mfma_f32_16x16x32_bf16 v[18:21], v[76:79], v[52:55], v[18:21]
    buffer_load_dwordx4 a[48:51], v1, s[68:71], s85 offen offset:0 sc1
    v_mfma_f32_16x16x32_bf16 v[14:17], v[56:59], v[88:91], v[14:17]
    s_lshl_b32 s86, s86, 12
    ds_read_b64 v[86:87], v212 offset:1416
    ds_read_b64 v[116:117], v212 offset:1920
    v_mfma_f32_16x16x32_bf16 v[10:13], v[64:67], v[88:91], v[10:13]
    s_and_b32 s80, s12, 1
    ds_read_b64 v[118:119], v212 offset:1928
    ds_read_b128 v[120:123], v213 offset:17568
    v_mfma_f32_16x16x32_bf16 v[6:9], v[72:75], v[88:91], v[6:9]
    ds_read_b64 v[124:125], v212 offset:2432
    v_accvgpr_write_b32 a249, 0
    v_mfma_f32_16x16x32_bf16 v[2:5], v[76:79], v[88:91], v[2:5]
    s_waitcnt lgkmcnt(11)
    s_lshl_b32 s80, s80, 9
    ds_read_b64 v[126:127], v212 offset:2440
    v_mfma_f32_16x16x32_bf16 v[14:17], v[64:67], v[92:95], v[14:17]
    buffer_load_dwordx4 a[52:55], v1, s[68:71], s85 offen offset:1024 sc1
    v_mfma_f32_16x16x32_bf16 v[10:13], v[72:75], v[92:95], v[10:13]
    s_add_u32 s86, s86, s80
    ds_read_b128 v[60:63], v213 offset:18080
    v_accvgpr_write_b32 a250, 0
    v_mfma_f32_16x16x32_bf16 v[6:9], v[76:79], v[92:95], v[6:9]
    s_nop 0
    ds_read_b64 v[48:49], v212 offset:2944
    ds_read_b64 v[50:51], v212 offset:2952
    v_mfma_f32_16x16x32_bf16 v[14:17], v[72:75], v[96:99], v[14:17]
    s_add_u32 s86, s86, 17825792
    ds_read_b128 v[68:71], v213 offset:18592
    ds_read_b64 v[112:113], v212 offset:3456
    v_mfma_f32_16x16x32_bf16 v[10:13], v[76:79], v[96:99], v[10:13]
    buffer_load_dwordx4 a[56:59], v1, s[68:71], s85 offen offset:2048 sc1
    v_mfma_f32_16x16x32_bf16 v[14:17], v[76:79], v[100:103], v[14:17]
    s_waitcnt lgkmcnt(11)
    s_lshl_b32 s82, s12, 4
    ds_read_b64 v[114:115], v212 offset:3464
    v_mfma_f32_16x16x32_bf16 v[14:17], v[108:111], v[104:107], v[14:17]
    ds_read_b64 v[52:53], v212 offset:3968
    v_accvgpr_write_b32 a251, 0
    v_mfma_f32_16x16x32_bf16 v[10:13], v[80:83], v[104:107], v[10:13]
    s_waitcnt lgkmcnt(9)
    s_add_u32 s82, s82, s3
    ds_read_b64 v[54:55], v212 offset:3976
    v_mfma_f32_16x16x32_bf16 v[6:9], v[84:87], v[104:107], v[6:9]
    buffer_load_dwordx4 a[60:63], v1, s[68:71], s85 offen offset:3072 sc1
    v_mfma_f32_16x16x32_bf16 v[2:5], v[116:119], v[104:107], v[2:5]
    s_mul_i32 s82, s82, 12288
    s_add_u32 s85, s85, 40960
    ds_read_b128 v[56:59], v213 offset:19104
    v_mfma_f32_16x16x32_bf16 v[14:17], v[80:83], v[120:123], v[14:17]
    ds_read_b128 v[88:91], v213 offset:19616
    v_mfma_f32_16x16x32_bf16 v[10:13], v[84:87], v[120:123], v[10:13]
    s_add_u32 s82, s82, 7340032
    ds_read_b128 v[64:67], v213 offset:20128
    v_mfma_f32_16x16x32_bf16 v[6:9], v[116:119], v[120:123], v[6:9]
    s_waitcnt lgkmcnt(8)
    ds_read_b128 v[92:95], v213 offset:20640
    v_mfma_f32_16x16x32_bf16 v[2:5], v[124:127], v[120:123], v[2:5]
    global_load_ushort a240, v45, s[42:43] offset:0
    v_mfma_f32_16x16x32_bf16 v[14:17], v[84:87], v[60:63], v[14:17]
    buffer_load_dwordx4 a[64:67], v1, s[68:71], s85 offen offset:0 sc1
    v_mfma_f32_16x16x32_bf16 v[10:13], v[116:119], v[60:63], v[10:13]
    s_and_b32 s80, s10, 7
    s_add_u32 s80, s80, s3
    ds_read_b128 v[72:75], v213 offset:16992
    v_mfma_f32_16x16x32_bf16 v[6:9], v[124:127], v[60:63], v[6:9]
    ds_read_b64 v[96:97], v212 offset:320
    ds_read_b64 v[98:99], v212 offset:328
    v_mfma_f32_16x16x32_bf16 v[2:5], v[48:51], v[60:63], v[2:5]
    s_waitcnt lgkmcnt(7)
    s_mul_i32 s73, s3, 4224
    ds_read_b64 v[100:101], v212 offset:832
    v_mfma_f32_16x16x32_bf16 v[14:17], v[116:119], v[68:71], v[14:17]
    buffer_load_dwordx4 a[68:71], v1, s[68:71], s85 offen offset:1024 sc1
    v_mfma_f32_16x16x32_bf16 v[10:13], v[124:127], v[68:71], v[10:13]
    s_add_u32 s95, s95, s73
    ds_read_b64 v[102:103], v212 offset:840
    ds_read_b64 v[76:77], v212 offset:1344
    v_mfma_f32_16x16x32_bf16 v[6:9], v[48:51], v[68:71], v[6:9]
    ds_read_b64 v[78:79], v212 offset:1352
    ds_read_b64 v[108:109], v212 offset:1856
    v_mfma_f32_16x16x32_bf16 v[2:5], v[112:115], v[68:71], v[2:5]
    s_cmp_eq_u32 s80, 8
    s_cselect_b32 s95, 1073741824, s95
    ds_read_b64 v[110:111], v212 offset:1864
    v_mfma_f32_16x16x32_bf16 v[18:21], v[112:115], v[104:107], v[18:21]
    global_load_ushort a242, v45, s[42:43] offset:32
    v_mfma_f32_16x16x32_bf16 v[18:21], v[52:55], v[120:123], v[18:21]
    s_waitcnt lgkmcnt(9)
    ds_read_b128 v[80:83], v213 offset:17504
    ds_read_b64 v[84:85], v212 offset:2368
    v_mfma_f32_16x16x32_bf16 v[14:17], v[124:127], v[56:59], v[14:17]
    buffer_load_dwordx4 a[72:75], v1, s[68:71], s85 offen offset:2048 sc1
    v_mfma_f32_16x16x32_bf16 v[10:13], v[48:51], v[56:59], v[10:13]
    ds_read_b64 v[86:87], v212 offset:2376
    ds_read_b128 v[60:63], v213 offset:18016
    v_mfma_f32_16x16x32_bf16 v[6:9], v[112:115], v[56:59], v[6:9]
    ds_read_b64 v[116:117], v212 offset:2880
    ds_read_b64 v[118:119], v212 offset:2888
    v_mfma_f32_16x16x32_bf16 v[2:5], v[52:55], v[56:59], v[2:5]
    ds_read_b128 v[68:71], v213 offset:18528
    v_mfma_f32_16x16x32_bf16 v[14:17], v[48:51], v[88:91], v[14:17]
    s_waitcnt vmcnt(12)
    s_mov_b64 exec, 1
    buffer_store_dword v232, off, s[68:71], s81 sc1
    s_mov_b64 exec, -1
    v_mfma_f32_16x16x32_bf16 v[10:13], v[112:115], v[88:91], v[10:13]
    buffer_load_dwordx4 a[76:79], v1, s[68:71], s85 offen offset:3072 sc1
    v_mfma_f32_16x16x32_bf16 v[6:9], v[52:55], v[88:91], v[6:9]
    s_add_u32 s85, s85, 4096
    ds_read_b64 v[104:105], v212 offset:3392
    ds_read_b64 v[106:107], v212 offset:3400
    v_mfma_f32_16x16x32_bf16 v[14:17], v[112:115], v[64:67], v[14:17]
    ds_read_b64 v[120:121], v212 offset:3904
    ds_read_b64 v[122:123], v212 offset:3912
    v_mfma_f32_16x16x32_bf16 v[10:13], v[52:55], v[64:67], v[10:13]
    ds_read_b128 v[124:127], v213 offset:19040
    v_mfma_f32_16x16x32_bf16 v[14:17], v[52:55], v[92:95], v[14:17]
    s_waitcnt lgkmcnt(10)
    ds_read_b128 v[56:59], v213 offset:19552
    v_mfma_f32_16x16x32_bf16 v[14:17], v[96:99], v[72:75], v[14:17]
    global_load_ushort a244, v45, s[42:43] offset:64
    v_mfma_f32_16x16x32_bf16 v[10:13], v[100:103], v[72:75], v[10:13]
    buffer_load_dwordx4 a[80:83], v1, s[68:71], s85 offen offset:0 sc1
    v_mfma_f32_16x16x32_bf16 v[6:9], v[76:79], v[72:75], v[6:9]
    ds_read_b128 v[48:51], v213 offset:20064
    v_mfma_f32_16x16x32_bf16 v[2:5], v[108:111], v[72:75], v[2:5]
    ds_read_b128 v[88:91], v213 offset:20576
    v_mfma_f32_16x16x32_bf16 v[14:17], v[100:103], v[80:83], v[14:17]
    ds_read_b128 v[112:115], v213 offset:16928
    ds_read_b64 v[64:65], v212 offset:256
    v_mfma_f32_16x16x32_bf16 v[10:13], v[76:79], v[80:83], v[10:13]
    global_load_ushort a246, v45, s[42:43] offset:96
    v_mfma_f32_16x16x32_bf16 v[6:9], v[108:111], v[80:83], v[6:9]
    s_waitcnt lgkmcnt(8)
    ds_read_b64 v[66:67], v212 offset:264
    ds_read_b64 v[92:93], v212 offset:768
    v_mfma_f32_16x16x32_bf16 v[2:5], v[84:87], v[80:83], v[2:5]
    buffer_load_dwordx4 a[84:87], v1, s[68:71], s85 offen offset:1024 sc1
    v_mfma_f32_16x16x32_bf16 v[14:17], v[76:79], v[60:63], v[14:17]
    ds_read_b64 v[94:95], v212 offset:776
    ds_read_b64 v[52:53], v212 offset:1280
    v_mfma_f32_16x16x32_bf16 v[10:13], v[108:111], v[60:63], v[10:13]
    ds_read_b64 v[54:55], v212 offset:1288
    ds_read_b64 v[96:97], v212 offset:1792
    v_mfma_f32_16x16x32_bf16 v[6:9], v[84:87], v[60:63], v[6:9]
    ds_read_b64 v[98:99], v212 offset:1800
    ds_read_b128 v[100:103], v213 offset:17440
    v_mfma_f32_16x16x32_bf16 v[2:5], v[116:119], v[60:63], v[2:5]
    buffer_load_dwordx4 a[88:91], v1, s[68:71], s85 offen offset:2048 sc1
    v_mfma_f32_16x16x32_bf16 v[14:17], v[108:111], v[68:71], v[14:17]
    ds_read_b64 v[76:77], v212 offset:2304
    ds_read_b64 v[78:79], v212 offset:2312
    v_mfma_f32_16x16x32_bf16 v[10:13], v[84:87], v[68:71], v[10:13]
    ds_read_b128 v[60:63], v213 offset:17952
    ds_read_b64 v[108:109], v212 offset:2816
    v_mfma_f32_16x16x32_bf16 v[6:9], v[116:119], v[68:71], v[6:9]
    ds_read_b64 v[110:111], v212 offset:2824
    v_mfma_f32_16x16x32_bf16 v[2:5], v[104:107], v[68:71], v[2:5]
    global_load_ushort a248, v45, s[42:43] offset:128
    v_mfma_f32_16x16x32_bf16 v[18:21], v[104:107], v[72:75], v[18:21]
    s_waitcnt lgkmcnt(11)
    ds_read_b128 v[68:71], v213 offset:18464
    ds_read_b64 v[72:73], v212 offset:3328
    v_mfma_f32_16x16x32_bf16 v[18:21], v[120:123], v[80:83], v[18:21]
    buffer_load_dwordx4 a[92:95], v1, s[68:71], s85 offen offset:3072 sc1
    v_mfma_f32_16x16x32_bf16 v[14:17], v[84:87], v[124:127], v[14:17]
    s_add_u32 s85, s85, 4096
    s_add_u32 m0, s15, 0
    ds_read_b64 v[74:75], v212 offset:3336
    v_mfma_f32_16x16x32_bf16 v[10:13], v[116:119], v[124:127], v[10:13]
    ds_read_b64 v[80:81], v212 offset:3840
    ds_read_b64 v[82:83], v212 offset:3848
    v_mfma_f32_16x16x32_bf16 v[6:9], v[104:107], v[124:127], v[6:9]
    ds_read_b128 v[84:87], v213 offset:18976
    v_mfma_f32_16x16x32_bf16 v[2:5], v[120:123], v[124:127], v[2:5]
    buffer_load_dwordx4 a[96:99], v1, s[68:71], s85 offen offset:0 sc1
    v_mfma_f32_16x16x32_bf16 v[14:17], v[116:119], v[56:59], v[14:17]
    ds_read_b128 v[124:127], v213 offset:19488
    v_mfma_f32_16x16x32_bf16 v[10:13], v[104:107], v[56:59], v[10:13]
    ds_read_b128 v[116:119], v213 offset:20000
    v_mfma_f32_16x16x32_bf16 v[6:9], v[120:123], v[56:59], v[6:9]
    ds_read_b128 v[56:59], v213 offset:20512
    v_mfma_f32_16x16x32_bf16 v[14:17], v[104:107], v[48:51], v[14:17]
    buffer_load_dwordx4 a[100:103], v1, s[68:71], s85 offen offset:1024 sc1
    v_mfma_f32_16x16x32_bf16 v[10:13], v[120:123], v[48:51], v[10:13]
    ds_read_b128 v[104:107], v213 offset:16864
    ds_read_b64 v[48:49], v212 offset:192
    v_mfma_f32_16x16x32_bf16 v[14:17], v[120:123], v[88:91], v[14:17]
    ds_read_b64 v[50:51], v212 offset:200
    ds_read_b64 v[88:89], v212 offset:704
    v_mfma_f32_16x16x32_bf16 v[14:17], v[64:67], v[112:115], v[14:17]
    s_waitcnt lgkmcnt(10)
    ds_read_b64 v[90:91], v212 offset:712
    ds_read_b64 v[120:121], v212 offset:1216
    v_mfma_f32_16x16x32_bf16 v[10:13], v[92:95], v[112:115], v[10:13]
    buffer_load_dwordx4 v229, s[52:55], s14 offen lds
    v_mfma_f32_16x16x32_bf16 v[6:9], v[52:55], v[112:115], v[6:9]
    s_add_u32 m0, s15, 1024
    ds_read_b64 v[122:123], v212 offset:1224
    ds_read_b64 v[64:65], v212 offset:1728
    v_mfma_f32_16x16x32_bf16 v[2:5], v[96:99], v[112:115], v[2:5]
    ds_read_b64 v[66:67], v212 offset:1736
    v_mfma_f32_16x16x32_bf16 v[14:17], v[92:95], v[100:103], v[14:17]
    ds_read_b128 v[92:95], v213 offset:17376
    v_mfma_f32_16x16x32_bf16 v[10:13], v[52:55], v[100:103], v[10:13]
    buffer_load_dwordx4 a[104:107], v1, s[68:71], s85 offen offset:2048 sc1
    v_mfma_f32_16x16x32_bf16 v[6:9], v[96:99], v[100:103], v[6:9]
    v_mfma_f32_16x16x32_bf16 v[2:5], v[76:79], v[100:103], v[2:5]
    v_mfma_f32_16x16x32_bf16 v[14:17], v[52:55], v[60:63], v[14:17]
    ds_read_b64 v[52:53], v212 offset:2240
    ds_read_b64 v[54:55], v212 offset:2248
    v_mfma_f32_16x16x32_bf16 v[10:13], v[96:99], v[60:63], v[10:13]
    buffer_load_dwordx4 a[108:111], v1, s[68:71], s85 offen offset:3072 sc1
    v_mfma_f32_16x16x32_bf16 v[6:9], v[76:79], v[60:63], v[6:9]
    s_add_u32 s85, s85, 40960
    v_mfma_f32_16x16x32_bf16 v[2:5], v[108:111], v[60:63], v[2:5]
    ds_read_b128 v[60:63], v213 offset:17888
    v_mfma_f32_16x16x32_bf16 v[14:17], v[96:99], v[68:71], v[14:17]
    ds_read_b64 v[96:97], v212 offset:2752
    ds_read_b64 v[98:99], v212 offset:2760
    v_mfma_f32_16x16x32_bf16 v[10:13], v[76:79], v[68:71], v[10:13]
    buffer_load_dwordx4 v230, s[52:55], s14 offen lds
    v_mfma_f32_16x16x32_bf16 v[6:9], v[108:111], v[68:71], v[6:9]
    v_mfma_f32_16x16x32_bf16 v[2:5], v[72:75], v[68:71], v[2:5]
    s_add_u32 m0, s15, 2048
    ds_read_b128 v[68:71], v213 offset:18400
    v_mfma_f32_16x16x32_bf16 v[18:21], v[72:75], v[112:115], v[18:21]
    s_waitcnt lgkmcnt(6)
    ds_read_b64 v[112:113], v212 offset:3264
    ds_read_b64 v[114:115], v212 offset:3272
    v_mfma_f32_16x16x32_bf16 v[18:21], v[80:83], v[100:103], v[18:21]
    buffer_load_dwordx4 a[112:115], v1, s[68:71], s85 offen offset:0 sc1
    v_mfma_f32_16x16x32_bf16 v[14:17], v[76:79], v[84:87], v[14:17]
    ds_read_b64 v[100:101], v212 offset:3776
    ds_read_b64 v[102:103], v212 offset:3784
    v_mfma_f32_16x16x32_bf16 v[10:13], v[108:111], v[84:87], v[10:13]
    ds_read_b128 v[76:79], v213 offset:18912
    v_mfma_f32_16x16x32_bf16 v[6:9], v[72:75], v[84:87], v[6:9]
    v_mfma_f32_16x16x32_bf16 v[2:5], v[80:83], v[84:87], v[2:5]
    buffer_load_dwordx4 a[116:119], v1, s[68:71], s85 offen offset:1024 sc1
    v_mfma_f32_16x16x32_bf16 v[14:17], v[108:111], v[124:127], v[14:17]
    ds_read_b128 v[84:87], v213 offset:19424
    v_mfma_f32_16x16x32_bf16 v[10:13], v[72:75], v[124:127], v[10:13]
    ds_read_b128 v[108:111], v213 offset:19936
    v_mfma_f32_16x16x32_bf16 v[6:9], v[80:83], v[124:127], v[6:9]
    ds_read_b128 v[124:127], v213 offset:20448
    v_mfma_f32_16x16x32_bf16 v[14:17], v[72:75], v[116:119], v[14:17]
    buffer_load_dwordx4 a[120:123], v1, s[68:71], s85 offen offset:2048 sc1
    v_mfma_f32_16x16x32_bf16 v[10:13], v[80:83], v[116:119], v[10:13]
    ds_read_b128 v[72:75], v213 offset:16800
    ds_read_b64 v[116:117], v212 offset:128
    v_mfma_f32_16x16x32_bf16 v[14:17], v[80:83], v[56:59], v[14:17]
    ds_read_b64 v[118:119], v212 offset:136
    ds_read_b64 v[56:57], v212 offset:640
    v_mfma_f32_16x16x32_bf16 v[14:17], v[48:51], v[104:107], v[14:17]
    buffer_load_dwordx4 v231, s[52:55], s14 offen lds
    v_mfma_f32_16x16x32_bf16 v[10:13], v[88:91], v[104:107], v[10:13]
    ds_read_b64 v[58:59], v212 offset:648
    ds_read_b64 v[80:81], v212 offset:1152
    v_mfma_f32_16x16x32_bf16 v[6:9], v[120:123], v[104:107], v[6:9]
    ds_read_b64 v[82:83], v212 offset:1160
    ds_read_b64 v[48:49], v212 offset:1664
    v_mfma_f32_16x16x32_bf16 v[2:5], v[64:67], v[104:107], v[2:5]
    buffer_load_dword v233, v42, s[68:71], s86 offen sc1
    v_mfma_f32_16x16x32_bf16 v[14:17], v[88:91], v[92:95], v[14:17]
    ds_read_b64 v[50:51], v212 offset:1672
    ds_read_b128 v[88:91], v213 offset:17312
    v_mfma_f32_16x16x32_bf16 v[10:13], v[120:123], v[92:95], v[10:13]
    buffer_load_dwordx4 a[124:127], v1, s[68:71], s85 offen offset:3072 sc1
    v_mfma_f32_16x16x32_bf16 v[6:9], v[64:67], v[92:95], v[6:9]
    s_waitcnt lgkmcnt(10)
    s_add_u32 s85, s85, 4096
    v_mfma_f32_16x16x32_bf16 v[2:5], v[52:55], v[92:95], v[2:5]
    v_mfma_f32_16x16x32_bf16 v[14:17], v[120:123], v[60:63], v[14:17]
    ds_read_b64 v[120:121], v212 offset:2176
    ds_read_b64 v[122:123], v212 offset:2184
    v_mfma_f32_16x16x32_bf16 v[10:13], v[64:67], v[60:63], v[10:13]
    buffer_load_dwordx4 a[128:131], v1, s[68:71], s85 offen offset:0 sc1
    v_mfma_f32_16x16x32_bf16 v[6:9], v[52:55], v[60:63], v[6:9]
    v_mfma_f32_16x16x32_bf16 v[2:5], v[96:99], v[60:63], v[2:5]
    ds_read_b128 v[60:63], v213 offset:17824
    v_mfma_f32_16x16x32_bf16 v[14:17], v[64:67], v[68:71], v[14:17]
    ds_read_b64 v[64:65], v212 offset:2688
    ds_read_b64 v[66:67], v212 offset:2696
    v_mfma_f32_16x16x32_bf16 v[10:13], v[52:55], v[68:71], v[10:13]
    buffer_load_dwordx4 a[132:135], v1, s[68:71], s85 offen offset:1024 sc1
    v_mfma_f32_16x16x32_bf16 v[6:9], v[96:99], v[68:71], v[6:9]
    v_mfma_f32_16x16x32_bf16 v[2:5], v[112:115], v[68:71], v[2:5]
    ds_read_b128 v[68:71], v213 offset:18336
    v_mfma_f32_16x16x32_bf16 v[18:21], v[112:115], v[104:107], v[18:21]
    ds_read_b64 v[104:105], v212 offset:3200
    ds_read_b64 v[106:107], v212 offset:3208
    v_mfma_f32_16x16x32_bf16 v[18:21], v[100:103], v[92:95], v[18:21]
    buffer_load_dwordx4 a[136:139], v1, s[68:71], s85 offen offset:2048 sc1
    v_mfma_f32_16x16x32_bf16 v[14:17], v[52:55], v[76:79], v[14:17]
    ds_read_b64 v[92:93], v212 offset:3712
    ds_read_b64 v[94:95], v212 offset:3720
    v_mfma_f32_16x16x32_bf16 v[10:13], v[96:99], v[76:79], v[10:13]
    ds_read_b128 v[52:55], v213 offset:18848
    v_mfma_f32_16x16x32_bf16 v[6:9], v[112:115], v[76:79], v[6:9]
    v_mfma_f32_16x16x32_bf16 v[2:5], v[100:103], v[76:79], v[2:5]
    buffer_load_dwordx4 a[140:143], v1, s[68:71], s85 offen offset:3072 sc1
    v_mfma_f32_16x16x32_bf16 v[14:17], v[96:99], v[84:87], v[14:17]
    s_add_u32 s85, s85, 4096
    ds_read_b128 v[76:79], v213 offset:19360
    v_mfma_f32_16x16x32_bf16 v[10:13], v[112:115], v[84:87], v[10:13]
    ds_read_b128 v[96:99], v213 offset:19872
    v_mfma_f32_16x16x32_bf16 v[6:9], v[100:103], v[84:87], v[6:9]
    ds_read_b128 v[84:87], v213 offset:20384
    v_mfma_f32_16x16x32_bf16 v[14:17], v[112:115], v[108:111], v[14:17]
    buffer_load_dwordx4 a[144:147], v1, s[68:71], s85 offen offset:0 sc1
    v_mfma_f32_16x16x32_bf16 v[10:13], v[100:103], v[108:111], v[10:13]
    ds_read_b128 v[112:115], v213 offset:16736
    ds_read_b64 v[108:109], v212 offset:64
    v_mfma_f32_16x16x32_bf16 v[14:17], v[100:103], v[124:127], v[14:17]
    s_waitcnt lgkmcnt(8)
    ds_read_b64 v[110:111], v212 offset:72
    ds_read_b64 v[124:125], v212 offset:576
    v_mfma_f32_16x16x32_bf16 v[14:17], v[116:119], v[72:75], v[14:17]
    ds_read_b64 v[126:127], v212 offset:584
    ds_read_b64 v[100:101], v212 offset:1088
    v_mfma_f32_16x16x32_bf16 v[10:13], v[56:59], v[72:75], v[10:13]
    buffer_load_dwordx4 a[148:151], v1, s[68:71], s85 offen offset:1024 sc1
    v_mfma_f32_16x16x32_bf16 v[6:9], v[80:83], v[72:75], v[6:9]
    ds_read_b64 v[102:103], v212 offset:1096
    ds_read_b64 v[116:117], v212 offset:1600
    v_mfma_f32_16x16x32_bf16 v[2:5], v[48:51], v[72:75], v[2:5]
    ds_read_b64 v[118:119], v212 offset:1608
    v_mfma_f32_16x16x32_bf16 v[14:17], v[56:59], v[88:91], v[14:17]
    ds_read_b128 v[56:59], v213 offset:17248
    v_mfma_f32_16x16x32_bf16 v[10:13], v[80:83], v[88:91], v[10:13]
    buffer_load_dwordx4 a[152:155], v1, s[68:71], s85 offen offset:2048 sc1
    v_mfma_f32_16x16x32_bf16 v[6:9], v[48:51], v[88:91], v[6:9]
    v_mfma_f32_16x16x32_bf16 v[2:5], v[120:123], v[88:91], v[2:5]
    v_mfma_f32_16x16x32_bf16 v[14:17], v[80:83], v[60:63], v[14:17]
    ds_read_b64 v[80:81], v212 offset:2112
    ds_read_b64 v[82:83], v212 offset:2120
    v_mfma_f32_16x16x32_bf16 v[10:13], v[48:51], v[60:63], v[10:13]
    buffer_load_dwordx4 a[156:159], v1, s[68:71], s85 offen offset:3072 sc1
    v_mfma_f32_16x16x32_bf16 v[6:9], v[120:123], v[60:63], v[6:9]
    v_mfma_f32_16x16x32_bf16 v[2:5], v[64:67], v[60:63], v[2:5]
    ds_read_b128 v[60:63], v213 offset:17760
    v_mfma_f32_16x16x32_bf16 v[14:17], v[48:51], v[68:71], v[14:17]
    ds_read_b64 v[48:49], v212 offset:2624
    ds_read_b64 v[50:51], v212 offset:2632
    v_mfma_f32_16x16x32_bf16 v[10:13], v[120:123], v[68:71], v[10:13]
    v_mfma_f32_16x16x32_bf16 v[6:9], v[64:67], v[68:71], v[6:9]
    v_mfma_f32_16x16x32_bf16 v[2:5], v[104:107], v[68:71], v[2:5]
    s_waitcnt vmcnt(9)
    v_cmp_ne_u32 vcc, s50, v233
    s_nop 0
    s_cmp_lg_u64 vcc, 0
    s_cbranch_scc1 L_slow_h0
L_ok_h0:
    v_mfma_f32_16x16x32_bf16 v[18:21], v[104:107], v[72:75], v[18:21]
    s_waitcnt lgkmcnt(5)
    s_add_u32 s72, s3, 1
    s_and_b32 s72, s72, 3
    v_mfma_f32_16x16x32_bf16 v[18:21], v[92:95], v[88:91], v[18:21]
    s_mul_i32 s72, s72, 49152
    s_add_u32 s72, s82, s72
    ds_read_b128 v[68:71], v213 offset:18272
    v_mfma_f32_16x16x32_bf16 v[14:17], v[120:123], v[52:55], v[14:17]
    buffer_load_dwordx4 v[128:131], v1, s[68:71], s72 offen offset:0 sc1
    v_mfma_f32_16x16x32_bf16 v[10:13], v[64:67], v[52:55], v[10:13]
    ds_read_b64 v[72:73], v212 offset:3136
    ds_read_b64 v[74:75], v212 offset:3144
    v_mfma_f32_16x16x32_bf16 v[6:9], v[104:107], v[52:55], v[6:9]
    ds_read_b64 v[88:89], v212 offset:3648
    ds_read_b64 v[90:91], v212 offset:3656
    v_mfma_f32_16x16x32_bf16 v[2:5], v[92:95], v[52:55], v[2:5]
    ds_read_b128 v[120:123], v213 offset:18784
    v_mfma_f32_16x16x32_bf16 v[14:17], v[64:67], v[76:79], v[14:17]
    buffer_load_dwordx4 v[132:135], v1, s[68:71], s72 offen offset:1024 sc1
    v_mfma_f32_16x16x32_bf16 v[10:13], v[104:107], v[76:79], v[10:13]
    ds_read_b128 v[52:55], v213 offset:19296
    v_mfma_f32_16x16x32_bf16 v[6:9], v[92:95], v[76:79], v[6:9]
    ds_read_b128 v[64:67], v213 offset:19808
    v_mfma_f32_16x16x32_bf16 v[14:17], v[104:107], v[96:99], v[14:17]
    ds_read_b128 v[76:79], v213 offset:20320
    v_mfma_f32_16x16x32_bf16 v[10:13], v[92:95], v[96:99], v[10:13]
    buffer_load_dwordx4 v[136:139], v1, s[68:71], s72 offen offset:2048 sc1
    v_mfma_f32_16x16x32_bf16 v[14:17], v[92:95], v[84:87], v[14:17]
    ds_read_b128 v[104:107], v213 offset:16672
    ds_read_b64 v[96:97], v212 offset:0
    v_mfma_f32_16x16x32_bf16 v[14:17], v[108:111], v[112:115], v[14:17]
    ds_read_b64 v[98:99], v212 offset:8
    ds_read_b64 v[84:85], v212 offset:512
    v_mfma_f32_16x16x32_bf16 v[10:13], v[124:127], v[112:115], v[10:13]
    ds_read_b64 v[86:87], v212 offset:520
    ds_read_b64 v[92:93], v212 offset:1024
    v_mfma_f32_16x16x32_bf16 v[6:9], v[100:103], v[112:115], v[6:9]
    buffer_load_dwordx4 v[140:143], v1, s[68:71], s72 offen offset:3072 sc1
    v_mfma_f32_16x16x32_bf16 v[2:5], v[116:119], v[112:115], v[2:5]
    s_add_u32 s72, s72, 4096
    ds_read_b64 v[94:95], v212 offset:1032
    ds_read_b64 v[108:109], v212 offset:1536
    v_mfma_f32_16x16x32_bf16 v[14:17], v[124:127], v[56:59], v[14:17]
    ds_read_b64 v[110:111], v212 offset:1544
    ds_read_b128 v[124:127], v213 offset:17184
    v_mfma_f32_16x16x32_bf16 v[10:13], v[100:103], v[56:59], v[10:13]
    v_mfma_f32_16x16x32_bf16 v[6:9], v[116:119], v[56:59], v[6:9]
    s_waitcnt lgkmcnt(11)
    v_mfma_f32_16x16x32_bf16 v[2:5], v[80:83], v[56:59], v[2:5]
    buffer_load_dwordx4 v[144:147], v1, s[68:71], s72 offen offset:0 sc1
    v_mfma_f32_16x16x32_bf16 v[14:17], v[100:103], v[60:63], v[14:17]
    ds_read_b64 v[100:101], v212 offset:2048
    ds_read_b64 v[102:103], v212 offset:2056
    v_mfma_f32_16x16x32_bf16 v[10:13], v[116:119], v[60:63], v[10:13]
    v_mfma_f32_16x16x32_bf16 v[6:9], v[80:83], v[60:63], v[6:9]
    v_mfma_f32_16x16x32_bf16 v[2:5], v[48:51], v[60:63], v[2:5]
    buffer_load_dwordx4 v[148:151], v1, s[68:71], s72 offen offset:1024 sc1
    v_mfma_f32_16x16x32_bf16 v[14:17], v[116:119], v[68:71], v[14:17]
    ds_read_b128 v[60:63], v213 offset:17696
    ds_read_b64 v[116:117], v212 offset:2560
    v_mfma_f32_16x16x32_bf16 v[10:13], v[80:83], v[68:71], v[10:13]
    ds_read_b64 v[118:119], v212 offset:2568
    v_mfma_f32_16x16x32_bf16 v[6:9], v[48:51], v[68:71], v[6:9]
    v_mfma_f32_16x16x32_bf16 v[2:5], v[72:75], v[68:71], v[2:5]
    buffer_load_dwordx4 v[152:155], v1, s[68:71], s72 offen offset:2048 sc1
    v_mfma_f32_16x16x32_bf16 v[18:21], v[72:75], v[112:115], v[18:21]
    ds_read_b128 v[68:71], v213 offset:18208
    ds_read_b64 v[112:113], v212 offset:3072
    v_mfma_f32_16x16x32_bf16 v[18:21], v[88:91], v[56:59], v[18:21]
    ds_read_b64 v[114:115], v212 offset:3080
    ds_read_b64 v[56:57], v212 offset:3584
    v_mfma_f32_16x16x32_bf16 v[14:17], v[80:83], v[120:123], v[14:17]
    ds_read_b64 v[58:59], v212 offset:3592
    v_mfma_f32_16x16x32_bf16 v[10:13], v[48:51], v[120:123], v[10:13]
    buffer_load_dwordx4 v[156:159], v1, s[68:71], s72 offen offset:3072 sc1
    v_mfma_f32_16x16x32_bf16 v[6:9], v[72:75], v[120:123], v[6:9]
    s_add_u32 s72, s72, 4096
    ds_read_b128 v[80:83], v213 offset:18720
    v_mfma_f32_16x16x32_bf16 v[2:5], v[88:91], v[120:123], v[2:5]
    ds_read_b128 v[120:123], v213 offset:19232
    v_mfma_f32_16x16x32_bf16 v[14:17], v[48:51], v[52:55], v[14:17]
    ds_read_b128 v[48:51], v213 offset:19744
    v_mfma_f32_16x16x32_bf16 v[10:13], v[72:75], v[52:55], v[10:13]
    buffer_load_dwordx4 v[160:163], v1, s[68:71], s72 offen offset:0 sc1
    v_mfma_f32_16x16x32_bf16 v[6:9], v[88:91], v[52:55], v[6:9]
    ds_read_b128 v[52:55], v213 offset:20256
    v_mfma_f32_16x16x32_bf16 v[14:17], v[72:75], v[64:67], v[14:17]
    v_mfma_f32_16x16x32_bf16 v[10:13], v[88:91], v[64:67], v[10:13]
    s_waitcnt lgkmcnt(7)
    v_mfma_f32_16x16x32_bf16 v[14:17], v[88:91], v[76:79], v[14:17]
    buffer_load_dwordx4 v[164:167], v1, s[68:71], s72 offen offset:1024 sc1
    v_mfma_f32_16x16x32_bf16 v[14:17], v[96:99], v[104:107], v[14:17]
    v_mfma_f32_16x16x32_bf16 v[10:13], v[84:87], v[104:107], v[10:13]
    v_mfma_f32_16x16x32_bf16 v[6:9], v[92:95], v[104:107], v[6:9]
    v_mfma_f32_16x16x32_bf16 v[2:5], v[108:111], v[104:107], v[2:5]
    buffer_load_dwordx4 v[168:171], v1, s[68:71], s72 offen offset:2048 sc1
    v_mfma_f32_16x16x32_bf16 v[14:17], v[84:87], v[124:127], v[14:17]
    v_mfma_f32_16x16x32_bf16 v[10:13], v[92:95], v[124:127], v[10:13]
    v_mfma_f32_16x16x32_bf16 v[6:9], v[108:111], v[124:127], v[6:9]
    v_mfma_f32_16x16x32_bf16 v[2:5], v[100:103], v[124:127], v[2:5]
    buffer_load_dwordx4 v[172:175], v1, s[68:71], s72 offen offset:3072 sc1
    v_mfma_f32_16x16x32_bf16 v[14:17], v[92:95], v[60:63], v[14:17]
    s_add_u32 s72, s3, 2
    s_and_b32 s72, s72, 3
    s_mul_i32 s72, s72, 49152
    v_mfma_f32_16x16x32_bf16 v[10:13], v[108:111], v[60:63], v[10:13]
    s_add_u32 s72, s82, s72
    v_mfma_f32_16x16x32_bf16 v[6:9], v[100:103], v[60:63], v[6:9]
    v_mfma_f32_16x16x32_bf16 v[2:5], v[116:119], v[60:63], v[2:5]
    buffer_load_dwordx4 v[176:179], v1, s[68:71], s72 offen offset:0 sc1
    v_mfma_f32_16x16x32_bf16 v[14:17], v[108:111], v[68:71], v[14:17]
    v_mfma_f32_16x16x32_bf16 v[10:13], v[100:103], v[68:71], v[10:13]
    v_mfma_f32_16x16x32_bf16 v[6:9], v[116:119], v[68:71], v[6:9]
    s_waitcnt lgkmcnt(0)
    v_mfma_f32_16x16x32_bf16 v[2:5], v[112:115], v[68:71], v[2:5]
    buffer_load_dwordx4 v[180:183], v1, s[68:71], s72 offen offset:1024 sc1
    v_mfma_f32_16x16x32_bf16 v[18:21], v[112:115], v[104:107], v[18:21]
    v_mfma_f32_16x16x32_bf16 v[18:21], v[56:59], v[124:127], v[18:21]
    v_mfma_f32_16x16x32_bf16 v[14:17], v[100:103], v[80:83], v[14:17]
    v_mfma_f32_16x16x32_bf16 v[10:13], v[116:119], v[80:83], v[10:13]
    v_mfma_f32_16x16x32_bf16 v[6:9], v[112:115], v[80:83], v[6:9]
    v_mfma_f32_16x16x32_bf16 v[2:5], v[56:59], v[80:83], v[2:5]
    v_mfma_f32_16x16x32_bf16 v[14:17], v[116:119], v[120:123], v[14:17]
    v_mfma_f32_16x16x32_bf16 v[10:13], v[112:115], v[120:123], v[10:13]
    v_mfma_f32_16x16x32_bf16 v[6:9], v[56:59], v[120:123], v[6:9]
    v_mfma_f32_16x16x32_bf16 v[14:17], v[112:115], v[48:51], v[14:17]
    v_mfma_f32_16x16x32_bf16 v[10:13], v[56:59], v[48:51], v[10:13]
    v_mfma_f32_16x16x32_bf16 v[14:17], v[56:59], v[52:55], v[14:17]
    v_cvt_pk_bf16_f32 v104, v18, v19
    v_cvt_pk_bf16_f32 v105, v20, v21
    v_cvt_pk_bf16_f32 v96, v2, v3
    v_cvt_pk_bf16_f32 v97, v4, v5
    s_nop 0
    v_cvt_pk_bf16_f32 v98, v6, v7
    s_nop 0
    v_cvt_pk_bf16_f32 v99, v8, v9
    v_cvt_pk_bf16_f32 v100, v10, v11
    v_cvt_pk_bf16_f32 v101, v12, v13
    v_cvt_pk_bf16_f32 v102, v14, v15
    v_cvt_pk_bf16_f32 v103, v16, v17
    ds_write_b64 v215, v[104:105] offset:2048
    ds_write_b64 v215, v[96:97] offset:0
    ds_write_b64 v215, v[98:99] offset:512
    ds_write_b64 v215, v[100:101] offset:1024
    ds_write_b64 v215, v[102:103] offset:1536
    buffer_load_dwordx4 v[184:187], v1, s[68:71], s72 offen offset:2048 sc1
    s_nop 1
    ds_read_b128 v[96:99], v216 offset:0
    ds_read_b128 v[100:103], v216 offset:1024
    ds_read_b128 v[104:107], v216 offset:2048
    buffer_load_dwordx4 v[188:191], v1, s[68:71], s72 offen offset:3072 sc1
    s_waitcnt lgkmcnt(2)
    buffer_store_dwordx4 v[96:99], v1, s[68:71], s95 offen offset:2048 sc1
    s_waitcnt lgkmcnt(1)
    buffer_store_dwordx4 v[100:103], v1, s[68:71], s95 offen offset:3072 sc1
    s_waitcnt lgkmcnt(0)
    buffer_store_dwordx4 v[104:107], v221, s[68:71], s95 offen offset:512 sc1
    s_branch L_g2
L_stub1:
    s_setpc_b64 s[88:89]
L_cv3:
    ds_read_b128 v[112:115], v213 offset:17120
    ds_read_b64 v[116:117], v212 offset:2496
    ds_read_b64 v[118:119], v212 offset:2504
    ds_read_b64 v[120:121], v212 offset:3008
    ds_read_b64 v[122:123], v212 offset:3016
    ds_read_b64 v[124:125], v212 offset:4032
    ds_read_b64 v[126:127], v212 offset:4040
    ds_read_b128 v[48:51], v213 offset:17632
    ds_read_b64 v[52:53], v212 offset:3520
    ds_read_b64 v[54:55], v212 offset:3528
    ds_read_b128 v[56:59], v213 offset:18144
    ds_read_b128 v[60:63], v213 offset:18656
    ds_read_b128 v[64:67], v213 offset:17056
    v_pk_mul_f32 v[2:3], v[104:105], v[104:105]
    v_pk_mul_f32 v[4:5], v[106:107], v[106:107]
    v_pk_fma_f32 v[2:3], v[2:3], v[8:9], v[8:9] op_sel:[0,1,0] op_sel_hi:[1,1,0]
    v_pk_fma_f32 v[4:5], v[4:5], v[8:9], v[8:9] op_sel:[0,1,0] op_sel_hi:[1,1,0]
    v_pk_mul_f32 v[2:3], v[2:3], v[104:105]
    v_pk_mul_f32 v[4:5], v[4:5], v[106:107]
    v_exp_f32 v2, v2
    v_exp_f32 v3, v3
    v_exp_f32 v4, v4
    v_exp_f32 v5, v5
    v_pk_fma_f32 v[2:3], v[2:3], v[30:31], v[30:31] op_sel_hi:[1,0,0]
    v_pk_fma_f32 v[4:5], v[4:5], v[30:31], v[30:31] op_sel_hi:[1,0,0]
    v_rcp_f32 v2, v2
    v_rcp_f32 v3, v3
    v_rcp_f32 v4, v4
    v_rcp_f32 v5, v5
    v_pk_mul_f32 v[2:3], v[2:3], v[104:105]
    v_pk_mul_f32 v[4:5], v[4:5], v[106:107]
    v_cvt_pk_bf16_f32 v84, v2, v3
    v_cvt_pk_bf16_f32 v85, v4, v5
    s_add_u32 s85, s85, 4096
    buffer_load_dwordx4 a[32:35], v1, s[68:71], s85 offen offset:0 sc1
    v_pk_mul_f32 v[2:3], v[108:109], v[108:109]
    v_pk_mul_f32 v[4:5], v[110:111], v[110:111]
    v_pk_fma_f32 v[2:3], v[2:3], v[8:9], v[8:9] op_sel:[0,1,0] op_sel_hi:[1,1,0]
    v_pk_fma_f32 v[4:5], v[4:5], v[8:9], v[8:9] op_sel:[0,1,0] op_sel_hi:[1,1,0]
    v_pk_mul_f32 v[2:3], v[2:3], v[108:109]
    v_pk_mul_f32 v[4:5], v[4:5], v[110:111]
    v_exp_f32 v2, v2
    v_exp_f32 v3, v3
    v_exp_f32 v4, v4
    v_exp_f32 v5, v5
    v_pk_fma_f32 v[2:3], v[2:3], v[30:31], v[30:31] op_sel_hi:[1,0,0]
    v_pk_fma_f32 v[4:5], v[4:5], v[30:31], v[30:31] op_sel_hi:[1,0,0]
    v_rcp_f32 v2, v2
    v_rcp_f32 v3, v3
    v_rcp_f32 v4, v4
    v_rcp_f32 v5, v5
    v_pk_mul_f32 v[2:3], v[2:3], v[108:109]
    v_pk_mul_f32 v[4:5], v[4:5], v[110:111]
    v_cvt_pk_bf16_f32 v86, v2, v3
    v_cvt_pk_bf16_f32 v87, v4, v5
    buffer_store_dwordx4 v[84:87], v239, s[68:71], s93 offen offset:512 sc1
    s_waitcnt lgkmcnt(10)
    v_mfma_f32_16x16x32_bf16 v[6:9], v[116:119], v[112:115], 0
    s_waitcnt lgkmcnt(8)
    ds_read_b64 v[68:69], v212 offset:2432
    ds_read_b64 v[70:71], v212 offset:2440
    v_mfma_f32_16x16x32_bf16 v[2:5], v[120:123], v[112:115], 0
    s_waitcnt lgkmcnt(8)
    ds_read_b64 v[72:73], v212 offset:2944
    ds_read_b64 v[74:75], v212 offset:2952
    ds_read_b64 v[76:77], v212 offset:3968
    v_mfma_f32_16x16x32_bf16 v[10:13], v[124:127], v[112:115], 0
    s_waitcnt lgkmcnt(10)
    ds_read_b64 v[78:79], v212 offset:3976
    ds_read_b128 v[88:91], v213 offset:17568
    ds_read_b64 v[92:93], v212 offset:3456
    v_mfma_f32_16x16x32_bf16 v[6:9], v[120:123], v[48:51], v[6:9]
    s_waitcnt lgkmcnt(11)
    s_lshl_b32 s81, s8, 4
    ds_read_b64 v[94:95], v212 offset:3464
    ds_read_b128 v[96:99], v213 offset:18080
    v_mfma_f32_16x16x32_bf16 v[2:5], v[52:55], v[48:51], v[2:5]
    s_waitcnt lgkmcnt(12)
    ds_read_b128 v[100:103], v213 offset:18592
    buffer_load_dwordx4 a[36:39], v1, s[68:71], s85 offen offset:1024 sc1
    v_mfma_f32_16x16x32_bf16 v[6:9], v[52:55], v[56:59], v[6:9]
    s_add_u32 s81, s81, s9
    ds_read_b128 v[104:107], v213 offset:16992
    ds_read_b64 v[108:109], v212 offset:2368
    v_mfma_f32_16x16x32_bf16 v[2:5], v[124:127], v[56:59], v[2:5]
    s_waitcnt lgkmcnt(14)
    ds_read_b64 v[110:111], v212 offset:2376
    ds_read_b64 v[80:81], v212 offset:2880
    v_accvgpr_write_b32 a241, 0
    v_mfma_f32_16x16x32_bf16 v[6:9], v[124:127], v[60:63], v[6:9]
    s_waitcnt lgkmcnt(13)
    s_lshl_b32 s81, s81, 2
    ds_read_b64 v[82:83], v212 offset:2888
    ds_read_b64 v[84:85], v212 offset:3904
    v_mfma_f32_16x16x32_bf16 v[6:9], v[68:71], v[64:67], v[6:9]
    s_waitcnt lgkmcnt(13)
    ds_read_b64 v[86:87], v212 offset:3912
    buffer_load_dwordx4 a[40:43], v1, s[68:71], s85 offen offset:2048 sc1
    v_mfma_f32_16x16x32_bf16 v[2:5], v[72:75], v[64:67], v[2:5]
    s_waitcnt lgkmcnt(12)
    s_add_u32 s81, s81, s3
    ds_read_b128 v[116:119], v213 offset:17504
    v_accvgpr_write_b32 a243, 0
    v_mfma_f32_16x16x32_bf16 v[10:13], v[76:79], v[64:67], v[10:13]
    s_waitcnt lgkmcnt(12)
    ds_read_b64 v[112:113], v212 offset:3392
    ds_read_b64 v[114:115], v212 offset:3400
    v_mfma_f32_16x16x32_bf16 v[6:9], v[72:75], v[88:91], v[6:9]
    s_waitcnt lgkmcnt(12)
    s_lshl_b32 s81, s81, 8
    ds_read_b128 v[120:123], v213 offset:18016
    ds_read_b128 v[48:51], v213 offset:18528
    v_mfma_f32_16x16x32_bf16 v[2:5], v[92:95], v[88:91], v[2:5]
    s_waitcnt lgkmcnt(13)
    buffer_load_dwordx4 a[44:47], v1, s[68:71], s85 offen offset:3072 sc1
    v_accvgpr_write_b32 a245, 0
    v_mfma_f32_16x16x32_bf16 v[6:9], v[92:95], v[96:99], v[6:9]
    s_add_u32 s81, s81, 17825792
    ds_read_b128 v[52:55], v213 offset:16928
    ds_read_b64 v[56:57], v212 offset:2304
    ds_read_b64 v[58:59], v212 offset:2312
    v_mfma_f32_16x16x32_bf16 v[2:5], v[76:79], v[96:99], v[2:5]
    s_waitcnt lgkmcnt(14)
    s_lshr_b32 s86, s12, 1
    ds_read_b64 v[60:61], v212 offset:2816
    ds_read_b64 v[62:63], v212 offset:2824
    v_mfma_f32_16x16x32_bf16 v[6:9], v[76:79], v[100:103], v[6:9]
    s_waitcnt lgkmcnt(14)
    ds_read_b64 v[124:125], v212 offset:3840
    ds_read_b64 v[126:127], v212 offset:3848
    v_mfma_f32_16x16x32_bf16 v[6:9], v[108:111], v[104:107], v[6:9]
    s_waitcnt lgkmcnt(14)
    s_add_u32 s85, s85, 4096
    ds_read_b128 v[68:71], v213 offset:17440
    v_accvgpr_write_b32 a247, 0
    v_mfma_f32_16x16x32_bf16 v[2:5], v[80:83], v[104:107], v[2:5]
    s_waitcnt lgkmcnt(13)
    s_lshl_b32 s86, s86, 2
    ds_read_b64 v[64:65], v212 offset:3328
    ds_read_b64 v[66:67], v212 offset:3336
    v_mfma_f32_16x16x32_bf16 v[10:13], v[84:87], v[104:107], v[10:13]
    s_waitcnt lgkmcnt(14)
    ds_read_b128 v[72:75], v213 offset:17952
    buffer_load_dwordx4 a[48:51], v1, s[68:71], s85 offen offset:0 sc1
    v_mfma_f32_16x16x32_bf16 v[6:9], v[80:83], v[116:119], v[6:9]
    s_waitcnt lgkmcnt(13)
    s_add_u32 s86, s86, s3
    ds_read_b128 v[88:91], v213 offset:18464
    v_accvgpr_write_b32 a249, 0
    v_mfma_f32_16x16x32_bf16 v[2:5], v[112:115], v[116:119], v[2:5]
    s_waitcnt lgkmcnt(13)
    s_lshl_b32 s86, s86, 12
    ds_read_b128 v[92:95], v213 offset:16864
    v_mfma_f32_16x16x32_bf16 v[6:9], v[112:115], v[120:123], v[6:9]
    buffer_load_dwordx4 a[52:55], v1, s[68:71], s85 offen offset:1024 sc1
    ds_read_b64 v[96:97], v212 offset:2240
    v_mfma_f32_16x16x32_bf16 v[2:5], v[84:87], v[120:123], v[2:5]
    s_waitcnt lgkmcnt(14)
    ds_read_b64 v[98:99], v212 offset:2248
    ds_read_b64 v[100:101], v212 offset:2752
    ds_read_b64 v[102:103], v212 offset:2760
    v_mfma_f32_16x16x32_bf16 v[6:9], v[84:87], v[48:51], v[6:9]
    s_waitcnt lgkmcnt(14)
    s_and_b32 s80, s12, 1
    ds_read_b64 v[76:77], v212 offset:3776
    v_accvgpr_write_b32 a250, 0
    v_mfma_f32_16x16x32_bf16 v[6:9], v[56:59], v[52:55], v[6:9]
    s_waitcnt lgkmcnt(13)
    s_lshl_b32 s80, s80, 9
    ds_read_b64 v[78:79], v212 offset:3784
    ds_read_b128 v[108:111], v213 offset:17376
    v_mfma_f32_16x16x32_bf16 v[2:5], v[60:63], v[52:55], v[2:5]
    s_waitcnt lgkmcnt(13)
    ds_read_b64 v[104:105], v212 offset:3264
    ds_read_b64 v[106:107], v212 offset:3272
    v_mfma_f32_16x16x32_bf16 v[10:13], v[124:127], v[52:55], v[10:13]
    s_waitcnt lgkmcnt(14)
    ds_read_b128 v[80:83], v213 offset:17888
    buffer_load_dwordx4 a[56:59], v1, s[68:71], s85 offen offset:2048 sc1
    v_mfma_f32_16x16x32_bf16 v[6:9], v[60:63], v[68:71], v[6:9]
    s_waitcnt lgkmcnt(13)
    s_add_u32 s86, s86, s80
    ds_read_b128 v[116:119], v213 offset:18400
    v_accvgpr_write_b32 a251, 0
    v_mfma_f32_16x16x32_bf16 v[2:5], v[64:67], v[68:71], v[2:5]
    s_waitcnt lgkmcnt(13)
    s_add_u32 s86, s86, 17825792
    ds_read_b128 v[112:115], v213 offset:16800
    ds_read_b64 v[120:121], v212 offset:2176
    v_mfma_f32_16x16x32_bf16 v[6:9], v[64:67], v[72:75], v[6:9]
    buffer_load_dwordx4 a[60:63], v1, s[68:71], s85 offen offset:3072 sc1
    ds_read_b64 v[122:123], v212 offset:2184
    v_mfma_f32_16x16x32_bf16 v[2:5], v[124:127], v[72:75], v[2:5]
    s_waitcnt lgkmcnt(14)
    ds_read_b64 v[48:49], v212 offset:2688
    ds_read_b64 v[50:51], v212 offset:2696
    v_mfma_f32_16x16x32_bf16 v[6:9], v[124:127], v[88:91], v[6:9]
    s_waitcnt lgkmcnt(14)
    s_lshl_b32 s82, s12, 4
    ds_read_b64 v[84:85], v212 offset:3712
    ds_read_b64 v[86:87], v212 offset:3720
    v_mfma_f32_16x16x32_bf16 v[6:9], v[96:99], v[92:95], v[6:9]
    s_waitcnt lgkmcnt(14)
    ds_read_b128 v[56:59], v213 offset:17312
    global_load_ushort a240, v45, s[42:43] offset:0
    v_mfma_f32_16x16x32_bf16 v[2:5], v[100:103], v[92:95], v[2:5]
    s_waitcnt lgkmcnt(13)
    s_add_u32 s82, s82, s3
    ds_read_b64 v[52:53], v212 offset:3200
    ds_read_b64 v[54:55], v212 offset:3208
    v_mfma_f32_16x16x32_bf16 v[10:13], v[76:79], v[92:95], v[10:13]
    s_waitcnt lgkmcnt(14)
    s_add_u32 s85, s85, 40960
    s_mul_i32 s82, s82, 12288
    ds_read_b128 v[60:63], v213 offset:17824
    v_mfma_f32_16x16x32_bf16 v[6:9], v[100:103], v[108:111], v[6:9]
    s_waitcnt lgkmcnt(13)
    buffer_load_dwordx4 a[64:67], v1, s[68:71], s85 offen offset:0 sc1
    v_mfma_f32_16x16x32_bf16 v[2:5], v[104:107], v[108:111], v[2:5]
    s_waitcnt lgkmcnt(12)
    s_add_u32 s82, s82, 7340032
    ds_read_b128 v[68:71], v213 offset:18336
    ds_read_b128 v[64:67], v213 offset:16736
    v_mfma_f32_16x16x32_bf16 v[6:9], v[104:107], v[80:83], v[6:9]
    s_and_b32 s80, s10, 7
    ds_read_b64 v[72:73], v212 offset:2112
    ds_read_b64 v[74:75], v212 offset:2120
    ds_read_b64 v[88:89], v212 offset:2624
    v_mfma_f32_16x16x32_bf16 v[2:5], v[76:79], v[80:83], v[2:5]
    s_waitcnt lgkmcnt(14)
    ds_read_b64 v[90:91], v212 offset:2632
    global_load_ushort a242, v45, s[42:43] offset:32
    v_mfma_f32_16x16x32_bf16 v[6:9], v[76:79], v[116:119], v[6:9]
    s_waitcnt lgkmcnt(14)
    ds_read_b64 v[124:125], v212 offset:3648
    ds_read_b64 v[126:127], v212 offset:3656
    ds_read_b128 v[96:99], v213 offset:17248
    v_mfma_f32_16x16x32_bf16 v[6:9], v[120:123], v[112:115], v[6:9]
    s_waitcnt lgkmcnt(14)
    buffer_load_dwordx4 a[68:71], v1, s[68:71], s85 offen offset:1024 sc1
    v_mfma_f32_16x16x32_bf16 v[2:5], v[48:51], v[112:115], v[2:5]
    s_waitcnt lgkmcnt(13)
    ds_read_b64 v[92:93], v212 offset:3136
    ds_read_b64 v[94:95], v212 offset:3144
    ds_read_b128 v[100:103], v213 offset:17760
    v_mfma_f32_16x16x32_bf16 v[10:13], v[84:87], v[112:115], v[10:13]
    s_waitcnt lgkmcnt(14)
    s_waitcnt vmcnt(11)
    s_mov_b64 exec, 1
    buffer_store_dword v232, off, s[68:71], s81 sc1
    s_mov_b64 exec, -1
    v_mfma_f32_16x16x32_bf16 v[6:9], v[48:51], v[56:59], v[6:9]
    s_waitcnt lgkmcnt(13)
    ds_read_b128 v[108:111], v213 offset:18272
    ds_read_b128 v[104:107], v213 offset:16672
    v_mfma_f32_16x16x32_bf16 v[2:5], v[52:55], v[56:59], v[2:5]
    s_waitcnt lgkmcnt(14)
    ds_read_b64 v[80:81], v212 offset:2048
    buffer_load_dwordx4 a[72:75], v1, s[68:71], s85 offen offset:2048 sc1
    v_mfma_f32_16x16x32_bf16 v[6:9], v[52:55], v[60:63], v[6:9]
    ds_read_b64 v[82:83], v212 offset:2056
    ds_read_b64 v[116:117], v212 offset:2560
    v_mfma_f32_16x16x32_bf16 v[2:5], v[84:87], v[60:63], v[2:5]
    s_waitcnt lgkmcnt(14)
    ds_read_b64 v[118:119], v212 offset:2568
    ds_read_b64 v[76:77], v212 offset:3584
    ds_read_b64 v[78:79], v212 offset:3592
    v_mfma_f32_16x16x32_bf16 v[6:9], v[84:87], v[68:71], v[6:9]
    s_waitcnt lgkmcnt(14)
    ds_read_b128 v[120:123], v213 offset:17184
    global_load_ushort a244, v45, s[42:43] offset:64
    v_mfma_f32_16x16x32_bf16 v[6:9], v[72:75], v[64:67], v[6:9]
    buffer_load_dwordx4 a[76:79], v1, s[68:71], s85 offen offset:3072 sc1
    ds_read_b64 v[112:113], v212 offset:3072
    v_mfma_f32_16x16x32_bf16 v[2:5], v[88:91], v[64:67], v[2:5]
    s_waitcnt lgkmcnt(13)
    s_add_u32 s85, s85, 4096
    ds_read_b64 v[114:115], v212 offset:3080
    ds_read_b128 v[48:51], v213 offset:17696
    v_mfma_f32_16x16x32_bf16 v[10:13], v[124:127], v[64:67], v[10:13]
    ds_read_b128 v[56:59], v213 offset:18208
    ds_read_b128 v[52:55], v213 offset:38400
    v_mfma_f32_16x16x32_bf16 v[6:9], v[88:91], v[96:99], v[6:9]
    s_waitcnt lgkmcnt(14)
    ds_read_b64 v[60:61], v212 offset:23776
    global_load_ushort a246, v45, s[42:43] offset:96
    v_mfma_f32_16x16x32_bf16 v[2:5], v[92:95], v[96:99], v[2:5]
    buffer_load_dwordx4 a[80:83], v1, s[68:71], s85 offen offset:0 sc1
    ds_read_b64 v[62:63], v212 offset:23784
    v_mfma_f32_16x16x32_bf16 v[6:9], v[92:95], v[100:103], v[6:9]
    ds_read_b64 v[68:69], v212 offset:24288
    ds_read_b64 v[70:71], v212 offset:24296
    ds_read_b64 v[84:85], v212 offset:25312
    v_mfma_f32_16x16x32_bf16 v[2:5], v[124:127], v[100:103], v[2:5]
    s_waitcnt lgkmcnt(14)
    ds_read_b64 v[86:87], v212 offset:25320
    ds_read_b128 v[72:75], v213 offset:38912
    ds_read_b64 v[64:65], v212 offset:24800
    v_mfma_f32_16x16x32_bf16 v[6:9], v[124:127], v[108:111], v[6:9]
    buffer_load_dwordx4 a[84:87], v1, s[68:71], s85 offen offset:1024 sc1
    v_mfma_f32_16x16x32_bf16 v[6:9], v[80:83], v[104:107], v[6:9]
    s_waitcnt lgkmcnt(14)
    ds_read_b64 v[66:67], v212 offset:24808
    ds_read_b128 v[88:91], v213 offset:39424
    v_mfma_f32_16x16x32_bf16 v[2:5], v[116:119], v[104:107], v[2:5]
    ds_read_b128 v[96:99], v213 offset:39936
    ds_read_b128 v[92:95], v213 offset:38336
    v_mfma_f32_16x16x32_bf16 v[10:13], v[76:79], v[104:107], v[10:13]
    s_waitcnt lgkmcnt(14)
    ds_read_b64 v[100:101], v212 offset:23712
    ds_read_b64 v[102:103], v212 offset:23720
    ds_read_b64 v[108:109], v212 offset:24224
    v_mfma_f32_16x16x32_bf16 v[6:9], v[116:119], v[120:123], v[6:9]
    global_load_ushort a248, v45, s[42:43] offset:128
    ds_read_b64 v[110:111], v212 offset:24232
    v_mfma_f32_16x16x32_bf16 v[2:5], v[112:115], v[120:123], v[2:5]
    buffer_load_dwordx4 a[88:91], v1, s[68:71], s85 offen offset:2048 sc1
    v_mfma_f32_16x16x32_bf16 v[6:9], v[112:115], v[48:51], v[6:9]
    ds_read_b64 v[124:125], v212 offset:25248
    ds_read_b64 v[126:127], v212 offset:25256
    ds_read_b128 v[80:83], v213 offset:38848
    v_mfma_f32_16x16x32_bf16 v[2:5], v[76:79], v[48:51], v[2:5]
    s_waitcnt lgkmcnt(14)
    ds_read_b64 v[104:105], v212 offset:24736
    ds_read_b64 v[106:107], v212 offset:24744
    v_mfma_f32_16x16x32_bf16 v[6:9], v[76:79], v[56:59], v[6:9]
    s_add_u32 m0, s15, 0
    ds_read_b128 v[116:119], v213 offset:39360
    ds_read_b128 v[120:123], v213 offset:39872
    v_mfma_f32_16x16x32_bf16 v[18:21], v[60:63], v[52:55], 0
    buffer_load_dwordx4 a[92:95], v1, s[68:71], s85 offen offset:3072 sc1
    ds_read_b128 v[112:115], v213 offset:38272
    v_mfma_f32_16x16x32_bf16 v[14:17], v[68:71], v[52:55], 0
    s_waitcnt lgkmcnt(14)
    ds_read_b64 v[48:49], v212 offset:23648
    ds_read_b64 v[50:51], v212 offset:23656
    v_mfma_f32_16x16x32_bf16 v[22:25], v[84:87], v[52:55], 0
    s_add_u32 s85, s85, 4096
    ds_read_b64 v[56:57], v212 offset:24160
    ds_read_b64 v[58:59], v212 offset:24168
    ds_read_b64 v[76:77], v212 offset:25184
    v_mfma_f32_16x16x32_bf16 v[18:21], v[68:71], v[72:75], v[18:21]
    buffer_load_dwordx4 v229, s[52:55], s14 offen lds
    v_cvt_pk_bf16_f32 v2, v2, v3
    v_mfma_f32_16x16x32_bf16 v[14:17], v[64:67], v[72:75], v[14:17]
    ds_read_b64 v[78:79], v212 offset:25192
    v_cvt_pk_bf16_f32 v3, v4, v5
    v_cvt_pk_bf16_f32 v4, v6, v7
    v_mfma_f32_16x16x32_bf16 v[18:21], v[64:67], v[88:91], v[18:21]
    ds_read_b128 v[60:63], v213 offset:38784
    ds_read_b64 v[52:53], v212 offset:24672
    v_cvt_pk_bf16_f32 v5, v8, v9
    v_mfma_f32_16x16x32_bf16 v[14:17], v[84:87], v[88:91], v[14:17]
    s_waitcnt lgkmcnt(14)
    buffer_load_dwordx4 a[96:99], v1, s[68:71], s85 offen offset:0 sc1
    v_mfma_f32_16x16x32_bf16 v[18:21], v[84:87], v[96:99], v[18:21]
    ds_read_b64 v[54:55], v212 offset:24680
    ds_read_b128 v[68:71], v213 offset:39296
    v_cvt_pk_bf16_f32 v6, v10, v11
    v_mfma_f32_16x16x32_bf16 v[18:21], v[100:103], v[92:95], v[18:21]
    ds_read_b128 v[72:75], v213 offset:39808
    ds_read_b128 v[64:67], v213 offset:38208
    v_cvt_pk_bf16_f32 v7, v12, v13
    v_mfma_f32_16x16x32_bf16 v[14:17], v[108:111], v[92:95], v[14:17]
    buffer_load_dwordx4 a[100:103], v1, s[68:71], s85 offen offset:1024 sc1
    s_add_u32 m0, s15, 1024
    v_mfma_f32_16x16x32_bf16 v[22:25], v[124:127], v[92:95], v[22:25]
    s_waitcnt lgkmcnt(12)
    ds_read_b64 v[88:89], v212 offset:23584
    ds_read_b64 v[90:91], v212 offset:23592
    ds_read_b64 v[96:97], v212 offset:24096
    v_mfma_f32_16x16x32_bf16 v[18:21], v[108:111], v[80:83], v[18:21]
    ds_read_b64 v[98:99], v212 offset:24104
    ds_read_b64 v[84:85], v212 offset:25120
    v_mfma_f32_16x16x32_bf16 v[14:17], v[104:107], v[80:83], v[14:17]
    buffer_load_dwordx4 a[104:107], v1, s[68:71], s85 offen offset:2048 sc1
    ds_read_b64 v[86:87], v212 offset:25128
    v_mfma_f32_16x16x32_bf16 v[18:21], v[104:107], v[116:119], v[18:21]
    ds_write_b64 v215, v[2:3] offset:0
    v_mfma_f32_16x16x32_bf16 v[14:17], v[124:127], v[116:119], v[14:17]
    ds_read_b128 v[100:103], v213 offset:38720
    ds_read_b64 v[92:93], v212 offset:24608
    ds_read_b64 v[94:95], v212 offset:24616
    v_mfma_f32_16x16x32_bf16 v[18:21], v[124:127], v[120:123], v[18:21]
    s_waitcnt lgkmcnt(14)
    ds_read_b128 v[108:111], v213 offset:39232
    buffer_load_dwordx4 v230, s[52:55], s14 offen lds
    v_mfma_f32_16x16x32_bf16 v[18:21], v[48:51], v[112:115], v[18:21]
    ds_read_b128 v[80:83], v213 offset:39744
    ds_read_b128 v[104:107], v213 offset:38144
    v_mfma_f32_16x16x32_bf16 v[14:17], v[56:59], v[112:115], v[14:17]
    ds_write_b64 v215, v[4:5] offset:512
    v_mfma_f32_16x16x32_bf16 v[22:25], v[76:79], v[112:115], v[22:25]
    buffer_load_dwordx4 a[108:111], v1, s[68:71], s85 offen offset:3072 sc1
    ds_read_b64 v[116:117], v212 offset:23520
    v_mfma_f32_16x16x32_bf16 v[18:21], v[56:59], v[60:63], v[18:21]
    s_waitcnt lgkmcnt(14)
    ds_read_b64 v[118:119], v212 offset:23528
    ds_read_b64 v[120:121], v212 offset:24032
    ds_read_b64 v[122:123], v212 offset:24040
    v_mfma_f32_16x16x32_bf16 v[14:17], v[52:55], v[60:63], v[14:17]
    s_add_u32 m0, s15, 2048
    ds_write_b64 v215, v[6:7] offset:1024
    v_mfma_f32_16x16x32_bf16 v[18:21], v[52:55], v[68:71], v[18:21]
    s_add_u32 s85, s85, 40960
    ds_read_b64 v[124:125], v212 offset:25056
    ds_read_b64 v[126:127], v212 offset:25064
    v_mfma_f32_16x16x32_bf16 v[14:17], v[76:79], v[68:71], v[14:17]
    buffer_load_dwordx4 a[112:115], v1, s[68:71], s85 offen offset:0 sc1
    ds_read_b128 v[48:51], v213 offset:38656
    v_mfma_f32_16x16x32_bf16 v[18:21], v[76:79], v[72:75], v[18:21]
    s_waitcnt lgkmcnt(14)
    ds_read_b64 v[112:113], v212 offset:24544
    ds_read_b64 v[114:115], v212 offset:24552
    ds_read_b128 v[56:59], v213 offset:39168
    v_mfma_f32_16x16x32_bf16 v[18:21], v[88:91], v[64:67], v[18:21]
    ds_read_b128 v[2:5], v216 offset:0
    v_mfma_f32_16x16x32_bf16 v[14:17], v[96:99], v[64:67], v[14:17]
    buffer_load_dwordx4 v231, s[52:55], s14 offen lds
    ds_read_b128 v[60:63], v213 offset:39680
    v_mfma_f32_16x16x32_bf16 v[22:25], v[84:87], v[64:67], v[22:25]
    ds_read_b128 v[52:55], v213 offset:38080
    ds_read_b64 v[68:69], v212 offset:23456
    v_mfma_f32_16x16x32_bf16 v[18:21], v[96:99], v[100:103], v[18:21]
    s_waitcnt lgkmcnt(14)
    ds_read_b64 v[70:71], v212 offset:23464
    ds_read_b128 v[6:9], v216 offset:1024
    ds_read_b64 v[72:73], v212 offset:23968
    v_mfma_f32_16x16x32_bf16 v[14:17], v[92:95], v[100:103], v[14:17]
    buffer_load_dwordx4 a[116:119], v1, s[68:71], s85 offen offset:1024 sc1
    ds_read_b64 v[74:75], v212 offset:23976
    v_mfma_f32_16x16x32_bf16 v[18:21], v[92:95], v[108:111], v[18:21]
    ds_read_b64 v[76:77], v212 offset:24992
    ds_read_b64 v[78:79], v212 offset:25000
    ds_read_b128 v[88:91], v213 offset:38592
    v_mfma_f32_16x16x32_bf16 v[14:17], v[84:87], v[108:111], v[14:17]
    ds_read_b64 v[64:65], v212 offset:24480
    ds_read_b64 v[66:67], v212 offset:24488
    v_mfma_f32_16x16x32_bf16 v[18:21], v[84:87], v[80:83], v[18:21]
    s_waitcnt lgkmcnt(14)
    s_waitcnt lgkmcnt(12)
    buffer_store_dwordx4 v[2:5], v1, s[68:71], s95 offen offset:1024 sc1
    v_mfma_f32_16x16x32_bf16 v[18:21], v[116:119], v[104:107], v[18:21]
    ds_read_b128 v[96:99], v213 offset:39104
    ds_read_b128 v[100:103], v213 offset:39616
    v_mfma_f32_16x16x32_bf16 v[14:17], v[120:123], v[104:107], v[14:17]
    ds_read_b128 v[92:95], v213 offset:38016
    ds_read_b64 v[108:109], v212 offset:23392
    v_mfma_f32_16x16x32_bf16 v[22:25], v[124:127], v[104:107], v[22:25]
    buffer_load_dword v233, v42, s[68:71], s86 offen sc1
    ds_read_b64 v[110:111], v212 offset:23400
    v_mfma_f32_16x16x32_bf16 v[18:21], v[120:123], v[48:51], v[18:21]
    ds_read_b64 v[80:81], v212 offset:23904
    ds_read_b64 v[82:83], v212 offset:23912
    ds_read_b64 v[84:85], v212 offset:24928
    v_mfma_f32_16x16x32_bf16 v[14:17], v[112:115], v[48:51], v[14:17]
    ds_read_b64 v[86:87], v212 offset:24936
    ds_read_b128 v[116:119], v213 offset:38528
    v_mfma_f32_16x16x32_bf16 v[18:21], v[112:115], v[56:59], v[18:21]
    buffer_load_dwordx4 a[120:123], v1, s[68:71], s85 offen offset:2048 sc1
    ds_read_b64 v[104:105], v212 offset:24416
    v_mfma_f32_16x16x32_bf16 v[14:17], v[124:127], v[56:59], v[14:17]
    s_waitcnt lgkmcnt(14)
    buffer_store_dwordx4 v[6:9], v221, s[68:71], s95 offen sc1
    v_mfma_f32_16x16x32_bf16 v[18:21], v[124:127], v[60:63], v[18:21]
    ds_read_b64 v[106:107], v212 offset:24424
    ds_read_b128 v[120:123], v213 offset:39040
    v_mfma_f32_16x16x32_bf16 v[18:21], v[68:71], v[52:55], v[18:21]
    ds_read_b128 v[48:51], v213 offset:39552
    ds_read_b128 v[112:115], v213 offset:37952
    v_mfma_f32_16x16x32_bf16 v[14:17], v[72:75], v[52:55], v[14:17]
    ds_read_b64 v[56:57], v212 offset:23328
    ds_read_b64 v[58:59], v212 offset:23336
    v_mfma_f32_16x16x32_bf16 v[22:25], v[76:79], v[52:55], v[22:25]
    s_waitcnt lgkmcnt(14)
    ds_read_b64 v[60:61], v212 offset:23840
    ds_read_b64 v[62:63], v212 offset:23848
    ds_read_b64 v[124:125], v212 offset:24864
    v_mfma_f32_16x16x32_bf16 v[18:21], v[72:75], v[88:91], v[18:21]
    ds_read_b64 v[126:127], v212 offset:24872
    ds_read_b128 v[68:71], v213 offset:38464
    ds_read_b64 v[52:53], v212 offset:24352
    v_mfma_f32_16x16x32_bf16 v[14:17], v[64:67], v[88:91], v[14:17]
    ds_read_b64 v[54:55], v212 offset:24360
    ds_read_b128 v[72:75], v213 offset:38976
    v_mfma_f32_16x16x32_bf16 v[18:21], v[64:67], v[96:99], v[18:21]
    buffer_load_dwordx4 a[124:127], v1, s[68:71], s85 offen offset:3072 sc1
    s_add_u32 s85, s85, 4096
    v_mfma_f32_16x16x32_bf16 v[14:17], v[76:79], v[96:99], v[14:17]
    ds_read_b128 v[88:91], v213 offset:39488
    ds_read_b128 v[64:67], v213 offset:59680
    v_mfma_f32_16x16x32_bf16 v[18:21], v[76:79], v[100:103], v[18:21]
    s_waitcnt lgkmcnt(14)
    ds_read_b64 v[96:97], v212 offset:45056
    ds_read_b64 v[98:99], v212 offset:45064
    ds_read_b64 v[100:101], v212 offset:45568
    v_mfma_f32_16x16x32_bf16 v[18:21], v[108:111], v[92:95], v[18:21]
    buffer_load_dwordx4 a[128:131], v1, s[68:71], s85 offen offset:0 sc1
    ds_read_b64 v[102:103], v212 offset:45576
    v_mfma_f32_16x16x32_bf16 v[14:17], v[80:83], v[92:95], v[14:17]
    ds_read_b64 v[76:77], v212 offset:46592
    ds_read_b64 v[78:79], v212 offset:46600
    ds_read_b128 v[108:111], v213 offset:60192
    v_mfma_f32_16x16x32_bf16 v[22:25], v[84:87], v[92:95], v[22:25]
    ds_read_b64 v[92:93], v212 offset:46080
    ds_read_b64 v[94:95], v212 offset:46088
    v_mfma_f32_16x16x32_bf16 v[18:21], v[80:83], v[116:119], v[18:21]
    buffer_load_dwordx4 a[132:135], v1, s[68:71], s85 offen offset:1024 sc1
    v_mfma_f32_16x16x32_bf16 v[14:17], v[104:107], v[116:119], v[14:17]
    ds_read_b128 v[80:83], v213 offset:60704
    ds_read_b128 v[116:119], v213 offset:61216
    v_mfma_f32_16x16x32_bf16 v[18:21], v[104:107], v[120:123], v[18:21]
    ds_read_b128 v[104:107], v213 offset:59616
    v_mfma_f32_16x16x32_bf16 v[14:17], v[84:87], v[120:123], v[14:17]
    s_waitcnt lgkmcnt(14)
    ds_read_b64 v[120:121], v212 offset:44992
    ds_read_b64 v[122:123], v212 offset:45000
    v_mfma_f32_16x16x32_bf16 v[18:21], v[84:87], v[48:51], v[18:21]
    buffer_load_dwordx4 a[136:139], v1, s[68:71], s85 offen offset:2048 sc1
    ds_read_b64 v[48:49], v212 offset:45504
    v_mfma_f32_16x16x32_bf16 v[18:21], v[56:59], v[112:115], v[18:21]
    ds_read_b64 v[50:51], v212 offset:45512
    ds_read_b64 v[84:85], v212 offset:46528
    v_mfma_f32_16x16x32_bf16 v[14:17], v[60:63], v[112:115], v[14:17]
    ds_read_b64 v[86:87], v212 offset:46536
    ds_read_b128 v[56:59], v213 offset:60128
    v_mfma_f32_16x16x32_bf16 v[22:25], v[124:127], v[112:115], v[22:25]
    ds_read_b64 v[112:113], v212 offset:46016
    ds_read_b64 v[114:115], v212 offset:46024
    v_mfma_f32_16x16x32_bf16 v[18:21], v[60:63], v[68:71], v[18:21]
    buffer_load_dwordx4 a[140:143], v1, s[68:71], s85 offen offset:3072 sc1
    s_add_u32 s85, s85, 4096
    v_mfma_f32_16x16x32_bf16 v[14:17], v[52:55], v[68:71], v[14:17]
    ds_read_b128 v[60:63], v213 offset:60640
    ds_read_b128 v[68:71], v213 offset:61152
    v_mfma_f32_16x16x32_bf16 v[18:21], v[52:55], v[72:75], v[18:21]
    ds_read_b128 v[52:55], v213 offset:59552
    v_mfma_f32_16x16x32_bf16 v[14:17], v[124:127], v[72:75], v[14:17]
    s_waitcnt lgkmcnt(13)
    ds_read_b64 v[72:73], v212 offset:44928
    ds_read_b64 v[74:75], v212 offset:44936
    v_mfma_f32_16x16x32_bf16 v[18:21], v[124:127], v[88:91], v[18:21]
    buffer_load_dwordx4 a[144:147], v1, s[68:71], s85 offen offset:0 sc1
    ds_read_b64 v[88:89], v212 offset:45440
    v_mfma_f32_16x16x32_bf16 v[30:33], v[96:99], v[64:67], 0
    ds_read_b64 v[90:91], v212 offset:45448
    ds_read_b64 v[124:125], v212 offset:46464
    ds_read_b64 v[126:127], v212 offset:46472
    v_mfma_f32_16x16x32_bf16 v[26:29], v[100:103], v[64:67], 0
    ds_read_b128 v[96:99], v213 offset:60064
    v_mfma_f32_16x16x32_bf16 v[34:37], v[76:79], v[64:67], 0
    buffer_load_dwordx4 a[148:151], v1, s[68:71], s85 offen offset:1024 sc1
    v_mfma_f32_16x16x32_bf16 v[30:33], v[100:103], v[108:111], v[30:33]
    v_cvt_pk_bf16_f32 v14, v14, v15
    v_cvt_pk_bf16_f32 v15, v16, v17
    v_cvt_pk_bf16_f32 v16, v18, v19
    v_mfma_f32_16x16x32_bf16 v[26:29], v[92:95], v[108:111], v[26:29]
    s_waitcnt vmcnt(9)
    v_cmp_ne_u32 vcc, s50, v233
    s_nop 0
    s_cmp_lg_u64 vcc, 0
    s_cbranch_scc1 L_slow_h1
L_ok_h1:
    v_mfma_f32_16x16x32_bf16 v[30:33], v[92:95], v[80:83], v[30:33]
    buffer_load_dwordx4 a[152:155], v1, s[68:71], s85 offen offset:2048 sc1
    v_cvt_pk_bf16_f32 v17, v20, v21
    v_mfma_f32_16x16x32_bf16 v[26:29], v[76:79], v[80:83], v[26:29]
    s_add_u32 s72, s3, 1
    ds_read_b64 v[64:65], v212 offset:45952
    ds_read_b64 v[66:67], v212 offset:45960
    ds_read_b128 v[100:103], v213 offset:60576
    v_mfma_f32_16x16x32_bf16 v[30:33], v[76:79], v[116:119], v[30:33]
    s_waitcnt lgkmcnt(10)
    s_and_b32 s72, s72, 3
    v_cvt_pk_bf16_f32 v18, v22, v23
    v_mfma_f32_16x16x32_bf16 v[30:33], v[120:123], v[104:107], v[30:33]
    buffer_load_dwordx4 a[156:159], v1, s[68:71], s85 offen offset:3072 sc1
    v_cvt_pk_bf16_f32 v19, v24, v25
    v_mfma_f32_16x16x32_bf16 v[26:29], v[48:51], v[104:107], v[26:29]
    s_mul_i32 s72, s72, 49152
    s_add_u32 s72, s82, s72
    ds_read_b128 v[108:111], v213 offset:61088
    ds_read_b128 v[92:95], v213 offset:59488
    v_mfma_f32_16x16x32_bf16 v[34:37], v[84:87], v[104:107], v[34:37]
    ds_read_b64 v[80:81], v212 offset:44864
    ds_read_b64 v[82:83], v212 offset:44872
    ds_read_b64 v[116:117], v212 offset:45376
    v_mfma_f32_16x16x32_bf16 v[30:33], v[48:51], v[56:59], v[30:33]
    buffer_load_dwordx4 v[128:131], v1, s[68:71], s72 offen offset:0 sc1
    ds_read_b64 v[118:119], v212 offset:45384
    v_mfma_f32_16x16x32_bf16 v[26:29], v[112:115], v[56:59], v[26:29]
    ds_write_b64 v215, v[14:15] offset:1536
    v_mfma_f32_16x16x32_bf16 v[30:33], v[112:115], v[60:63], v[30:33]
    ds_read_b64 v[76:77], v212 offset:46400
    ds_read_b64 v[78:79], v212 offset:46408
    ds_read_b128 v[120:123], v213 offset:60000
    v_mfma_f32_16x16x32_bf16 v[26:29], v[84:87], v[60:63], v[26:29]
    buffer_load_dwordx4 v[132:135], v1, s[68:71], s72 offen offset:1024 sc1
    ds_read_b64 v[104:105], v212 offset:45888
    v_mfma_f32_16x16x32_bf16 v[30:33], v[84:87], v[68:71], v[30:33]
    s_waitcnt lgkmcnt(14)
    ds_read_b64 v[106:107], v212 offset:45896
    ds_read_b128 v[48:51], v213 offset:60512
    v_mfma_f32_16x16x32_bf16 v[30:33], v[72:75], v[52:55], v[30:33]
    ds_write_b64 v215, v[16:17] offset:2048
    v_mfma_f32_16x16x32_bf16 v[26:29], v[88:91], v[52:55], v[26:29]
    buffer_load_dwordx4 v[136:139], v1, s[68:71], s72 offen offset:2048 sc1
    v_mfma_f32_16x16x32_bf16 v[34:37], v[124:127], v[52:55], v[34:37]
    ds_read_b128 v[56:59], v213 offset:61024
    ds_read_b128 v[112:115], v213 offset:59424
    v_mfma_f32_16x16x32_bf16 v[30:33], v[88:91], v[96:99], v[30:33]
    s_waitcnt lgkmcnt(14)
    ds_read_b64 v[60:61], v212 offset:44800
    ds_read_b64 v[62:63], v212 offset:44808
    ds_read_b64 v[68:69], v212 offset:45312
    v_mfma_f32_16x16x32_bf16 v[26:29], v[64:67], v[96:99], v[26:29]
    ds_read_b64 v[70:71], v212 offset:45320
    ds_read_b64 v[84:85], v212 offset:46336
    ds_read_b64 v[86:87], v212 offset:46344
    v_mfma_f32_16x16x32_bf16 v[30:33], v[64:67], v[100:103], v[30:33]
    buffer_load_dwordx4 v[140:143], v1, s[68:71], s72 offen offset:3072 sc1
    ds_read_b128 v[72:75], v213 offset:59936
    v_mfma_f32_16x16x32_bf16 v[26:29], v[124:127], v[100:103], v[26:29]
    ds_write_b64 v215, v[18:19] offset:2560
    v_mfma_f32_16x16x32_bf16 v[30:33], v[124:127], v[108:111], v[30:33]
    s_waitcnt lgkmcnt(14)
    ds_read_b64 v[52:53], v212 offset:45824
    ds_read_b64 v[54:55], v212 offset:45832
    ds_read_b128 v[88:91], v213 offset:60448
    v_mfma_f32_16x16x32_bf16 v[30:33], v[80:83], v[92:95], v[30:33]
    s_add_u32 s72, s72, 4096
    ds_read_b128 v[14:17], v216 offset:1536
    buffer_load_dwordx4 v[144:147], v1, s[68:71], s72 offen offset:0 sc1
    v_mfma_f32_16x16x32_bf16 v[26:29], v[116:119], v[92:95], v[26:29]
    ds_read_b128 v[96:99], v213 offset:60960
    ds_read_b128 v[18:21], v216 offset:2560
    v_mfma_f32_16x16x32_bf16 v[34:37], v[76:79], v[92:95], v[34:37]
    ds_read_b128 v[64:67], v213 offset:59360
    ds_read_b64 v[100:101], v212 offset:44736
    v_mfma_f32_16x16x32_bf16 v[30:33], v[116:119], v[120:123], v[30:33]
    s_waitcnt lgkmcnt(14)
    s_add_u32 s95, s95, 4224
    ds_read_b64 v[102:103], v212 offset:44744
    v_mfma_f32_16x16x32_bf16 v[26:29], v[104:107], v[120:123], v[26:29]
    s_waitcnt lgkmcnt(5)
    buffer_store_dwordx4 v[14:17], v1, s[68:71], s95 offen offset:1024 sc1
    v_mfma_f32_16x16x32_bf16 v[30:33], v[104:107], v[48:51], v[30:33]
    ds_read_b64 v[108:109], v212 offset:45248
    ds_read_b64 v[110:111], v212 offset:45256
    ds_read_b64 v[124:125], v212 offset:46272
    v_mfma_f32_16x16x32_bf16 v[26:29], v[76:79], v[48:51], v[26:29]
    ds_read_b64 v[126:127], v212 offset:46280
    ds_read_b128 v[80:83], v213 offset:59872
    ds_read_b64 v[92:93], v212 offset:45760
    v_mfma_f32_16x16x32_bf16 v[30:33], v[76:79], v[56:59], v[30:33]
    ds_read_b64 v[94:95], v212 offset:45768
    ds_read_b128 v[116:119], v213 offset:60384
    v_mfma_f32_16x16x32_bf16 v[30:33], v[60:63], v[112:115], v[30:33]
    ds_read_b128 v[120:123], v213 offset:60896
    v_mfma_f32_16x16x32_bf16 v[26:29], v[68:71], v[112:115], v[26:29]
    buffer_load_dwordx4 v[148:151], v1, s[68:71], s72 offen offset:1024 sc1
    ds_read_b128 v[104:107], v213 offset:59296
    v_mfma_f32_16x16x32_bf16 v[34:37], v[84:87], v[112:115], v[34:37]
    ds_read_b64 v[48:49], v212 offset:44672
    ds_read_b64 v[50:51], v212 offset:44680
    ds_read_b64 v[56:57], v212 offset:45184
    v_mfma_f32_16x16x32_bf16 v[30:33], v[68:71], v[72:75], v[30:33]
    ds_read_b64 v[58:59], v212 offset:45192
    ds_read_b64 v[76:77], v212 offset:46208
    ds_read_b64 v[78:79], v212 offset:46216
    v_mfma_f32_16x16x32_bf16 v[26:29], v[52:55], v[72:75], v[26:29]
    buffer_load_dwordx4 v[152:155], v1, s[68:71], s72 offen offset:2048 sc1
    ds_read_b128 v[60:63], v213 offset:59808
    v_mfma_f32_16x16x32_bf16 v[30:33], v[52:55], v[88:91], v[30:33]
    ds_read_b64 v[112:113], v212 offset:45696
    ds_read_b64 v[114:115], v212 offset:45704
    v_mfma_f32_16x16x32_bf16 v[26:29], v[84:87], v[88:91], v[26:29]
    s_waitcnt lgkmcnt(14)
    buffer_store_dwordx4 v[18:21], v221, s[68:71], s95 offen sc1
    v_mfma_f32_16x16x32_bf16 v[30:33], v[84:87], v[96:99], v[30:33]
    ds_read_b128 v[68:71], v213 offset:60320
    ds_read_b128 v[72:75], v213 offset:60832
    v_mfma_f32_16x16x32_bf16 v[30:33], v[100:103], v[64:67], v[30:33]
    ds_read_b128 v[52:55], v213 offset:59232
    ds_read_b64 v[88:89], v212 offset:44608
    v_mfma_f32_16x16x32_bf16 v[26:29], v[108:111], v[64:67], v[26:29]
    ds_read_b64 v[90:91], v212 offset:44616
    ds_read_b64 v[96:97], v212 offset:45120
    ds_read_b64 v[98:99], v212 offset:45128
    v_mfma_f32_16x16x32_bf16 v[34:37], v[124:127], v[64:67], v[34:37]
    ds_read_b64 v[84:85], v212 offset:46144
    ds_read_b64 v[86:87], v212 offset:46152
    v_mfma_f32_16x16x32_bf16 v[30:33], v[108:111], v[80:83], v[30:33]
    s_waitcnt lgkmcnt(14)
    ds_read_b128 v[100:103], v213 offset:59744
    ds_read_b64 v[64:65], v212 offset:45632
    ds_read_b64 v[66:67], v212 offset:45640
    v_mfma_f32_16x16x32_bf16 v[26:29], v[92:95], v[80:83], v[26:29]
    buffer_load_dwordx4 v[156:159], v1, s[68:71], s72 offen offset:3072 sc1
    s_add_u32 s72, s72, 4096
    v_mfma_f32_16x16x32_bf16 v[30:33], v[92:95], v[116:119], v[30:33]
    ds_read_b128 v[108:111], v213 offset:60256
    ds_read_b128 v[80:83], v213 offset:60768
    v_mfma_f32_16x16x32_bf16 v[26:29], v[124:127], v[116:119], v[26:29]
    v_mfma_f32_16x16x32_bf16 v[30:33], v[124:127], v[120:123], v[30:33]
    v_mfma_f32_16x16x32_bf16 v[30:33], v[48:51], v[104:107], v[30:33]
    buffer_load_dwordx4 v[160:163], v1, s[68:71], s72 offen offset:0 sc1
    v_mfma_f32_16x16x32_bf16 v[26:29], v[56:59], v[104:107], v[26:29]
    s_waitcnt lgkmcnt(12)
    v_mfma_f32_16x16x32_bf16 v[34:37], v[76:79], v[104:107], v[34:37]
    v_mfma_f32_16x16x32_bf16 v[30:33], v[56:59], v[60:63], v[30:33]
    v_mfma_f32_16x16x32_bf16 v[26:29], v[112:115], v[60:63], v[26:29]
    buffer_load_dwordx4 v[164:167], v1, s[68:71], s72 offen offset:1024 sc1
    v_mfma_f32_16x16x32_bf16 v[30:33], v[112:115], v[68:71], v[30:33]
    v_mfma_f32_16x16x32_bf16 v[26:29], v[76:79], v[68:71], v[26:29]
    v_mfma_f32_16x16x32_bf16 v[30:33], v[76:79], v[72:75], v[30:33]
    s_waitcnt lgkmcnt(0)
    v_mfma_f32_16x16x32_bf16 v[30:33], v[88:91], v[52:55], v[30:33]
    buffer_load_dwordx4 v[168:171], v1, s[68:71], s72 offen offset:2048 sc1
    v_mfma_f32_16x16x32_bf16 v[26:29], v[96:99], v[52:55], v[26:29]
    v_mfma_f32_16x16x32_bf16 v[34:37], v[84:87], v[52:55], v[34:37]
    v_mfma_f32_16x16x32_bf16 v[30:33], v[96:99], v[100:103], v[30:33]
    v_mfma_f32_16x16x32_bf16 v[26:29], v[64:67], v[100:103], v[26:29]
    buffer_load_dwordx4 v[172:175], v1, s[68:71], s72 offen offset:3072 sc1
    s_add_u32 s72, s3, 2
    v_mfma_f32_16x16x32_bf16 v[30:33], v[64:67], v[108:111], v[30:33]
    s_and_b32 s72, s72, 3
    s_mul_i32 s72, s72, 49152
    s_add_u32 s72, s82, s72
    v_mfma_f32_16x16x32_bf16 v[26:29], v[84:87], v[108:111], v[26:29]
    v_mfma_f32_16x16x32_bf16 v[30:33], v[84:87], v[80:83], v[30:33]
    buffer_load_dwordx4 v[176:179], v1, s[68:71], s72 offen offset:0 sc1
    buffer_load_dwordx4 v[180:183], v1, s[68:71], s72 offen offset:1024 sc1
    s_nop 4
    v_cvt_pk_bf16_f32 v26, v26, v27
    v_cvt_pk_bf16_f32 v27, v28, v29
    v_cvt_pk_bf16_f32 v28, v30, v31
    v_cvt_pk_bf16_f32 v29, v32, v33
    v_cvt_pk_bf16_f32 v30, v34, v35
    v_cvt_pk_bf16_f32 v31, v36, v37
    ds_write_b64 v215, v[26:27] offset:3072
    ds_write_b64 v215, v[28:29] offset:3584
    ds_write_b64 v215, v[30:31] offset:4096
    buffer_load_dwordx4 v[184:187], v1, s[68:71], s72 offen offset:2048 sc1
    s_nop 1
    s_nop 0
    ds_read_b128 v[26:29], v216 offset:3072
    ds_read_b128 v[30:33], v216 offset:4096
    buffer_load_dwordx4 v[188:191], v1, s[68:71], s72 offen offset:3072 sc1
    s_add_u32 s95, s95, 4224
    s_cmp_eq_u32 s80, 6
    s_cselect_b32 s95, 1073741824, s95
    s_waitcnt lgkmcnt(1)
    buffer_store_dwordx4 v[26:29], v1, s[68:71], s95 offen offset:1024 sc1
    s_waitcnt lgkmcnt(0)
    buffer_store_dwordx4 v[30:33], v221, s[68:71], s95 offen sc1
    s_branch L_g2
L_stub2:
    s_setpc_b64 s[88:89]
L_g2:
    s_mul_i32 s75, s3, 10240
    s_add_u32 s75, s75, 32768
    s_mov_b32 m0, s75
    v_mfma_f32_16x16x32_bf16 v[2:5], a[240:243], v[252:255], 0
    s_waitcnt vmcnt(18)
    s_add_u32 s72, s72, 4096
    s_lshl_b32 s81, s6, 2
    v_mfma_f32_16x16x32_bf16 v[2:5], a[160:163], v[128:131], v[2:5]
    s_waitcnt vmcnt(17)
    s_add_u32 s81, s81, s3
    v_mfma_f32_16x16x32_bf16 v[2:5], a[164:167], v[132:135], v[2:5]
    s_waitcnt vmcnt(16)
    v_mfma_f32_16x16x32_bf16 v[2:5], a[168:171], v[136:139], v[2:5]
    s_waitcnt vmcnt(15)
    v_mfma_f32_16x16x32_bf16 v[2:5], a[172:175], v[140:143], v[2:5]
    s_waitcnt vmcnt(14)
    s_lshl_b32 s81, s81, 8
    v_mfma_f32_16x16x32_bf16 v[2:5], a[176:179], v[144:147], v[2:5]
    s_waitcnt vmcnt(13)
    v_mfma_f32_16x16x32_bf16 v[2:5], a[180:183], v[148:151], v[2:5]
    s_waitcnt vmcnt(12)
    v_mfma_f32_16x16x32_bf16 v[2:5], a[184:187], v[152:155], v[2:5]
    s_waitcnt vmcnt(10)
    s_add_u32 s81, s81, 18087936
    v_mfma_f32_16x16x32_bf16 v[2:5], a[188:191], v[156:159], v[2:5]
    s_waitcnt vmcnt(9)
    buffer_load_dwordx4 v[192:195], v1, s[68:71], s72 offen offset:0 sc1
    v_mfma_f32_16x16x32_bf16 v[2:5], a[192:195], v[160:163], v[2:5]
    s_waitcnt vmcnt(9)
    v_mfma_f32_16x16x32_bf16 v[2:5], a[196:199], v[164:167], v[2:5]
    s_waitcnt vmcnt(8)
    s_lshl_b32 s86, s13, 15
    v_mfma_f32_16x16x32_bf16 v[2:5], a[200:203], v[168:171], v[2:5]
    s_waitcnt vmcnt(7)
    v_mfma_f32_16x16x32_bf16 v[2:5], a[204:207], v[172:175], v[2:5]
    buffer_load_dwordx4 v[196:199], v1, s[68:71], s72 offen offset:1024 sc1
    v_mfma_f32_16x16x32_bf16 v[6:9], a[242:245], v[252:255], 0
    s_add_u32 s86, s86, 18087936
    v_mfma_f32_16x16x32_bf16 v[6:9], a[208:211], v[128:131], v[6:9]
    v_mfma_f32_16x16x32_bf16 v[6:9], a[212:215], v[132:135], v[6:9]
    s_lshl_b32 s76, s13, 2
    v_mfma_f32_16x16x32_bf16 v[6:9], a[216:219], v[136:139], v[6:9]
    buffer_load_dwordx4 v[200:203], v1, s[68:71], s72 offen offset:2048 sc1
    v_mfma_f32_16x16x32_bf16 v[6:9], a[220:223], v[140:143], v[6:9]
    ds_write_addtid_b32 v2 offset:49152
    ds_write_addtid_b32 v3 offset:49408
    v_mfma_f32_16x16x32_bf16 v[6:9], a[224:227], v[144:147], v[6:9]
    s_add_u32 s76, s76, s3
    ds_write_addtid_b32 v4 offset:49664
    ds_write_addtid_b32 v5 offset:49920
    v_mfma_f32_16x16x32_bf16 v[6:9], a[228:231], v[148:151], v[6:9]
    v_mfma_f32_16x16x32_bf16 v[6:9], a[232:235], v[152:155], v[6:9]
    buffer_load_dwordx4 v[204:207], v1, s[68:71], s72 offen offset:3072 sc1
    v_mfma_f32_16x16x32_bf16 v[6:9], a[236:239], v[156:159], v[6:9]
    s_add_u32 s72, s72, 4096
    s_mul_i32 s76, s76, 84480
    v_mfma_f32_16x16x32_bf16 v[6:9], a[0:3], v[160:163], v[6:9]
    v_mfma_f32_16x16x32_bf16 v[6:9], a[4:7], v[164:167], v[6:9]
    v_mfma_f32_16x16x32_bf16 v[6:9], a[8:11], v[168:171], v[6:9]
    buffer_load_dwordx4 v[208:211], v1, s[68:71], s72 offen offset:0 sc1
    v_mfma_f32_16x16x32_bf16 v[6:9], a[12:15], v[172:175], v[6:9]
    s_lshl_b32 s80, s12, 7
    v_mfma_f32_16x16x32_bf16 v[10:13], a[244:247], v[252:255], 0
    s_add_u32 s76, s76, s80
    v_mfma_f32_16x16x32_bf16 v[10:13], a[16:19], v[128:131], v[10:13]
    v_mfma_f32_16x16x32_bf16 v[10:13], a[20:23], v[132:135], v[10:13]
    buffer_load_dwordx4 v[240:243], v1, s[68:71], s72 offen offset:1024 sc1
    v_mfma_f32_16x16x32_bf16 v[10:13], a[24:27], v[136:139], v[10:13]
    s_add_u32 s76, s76, 13631488
    ds_write_addtid_b32 v6 offset:50176
    ds_write_addtid_b32 v7 offset:50432
    v_mfma_f32_16x16x32_bf16 v[10:13], a[28:31], v[140:143], v[10:13]
    ds_write_addtid_b32 v8 offset:50688
    ds_write_addtid_b32 v9 offset:50944
    v_mfma_f32_16x16x32_bf16 v[10:13], a[32:35], v[144:147], v[10:13]
    v_mfma_f32_16x16x32_bf16 v[10:13], a[36:39], v[148:151], v[10:13]
    buffer_load_dwordx4 v[244:247], v1, s[68:71], s72 offen offset:2048 sc1
    v_mfma_f32_16x16x32_bf16 v[10:13], a[40:43], v[152:155], v[10:13]
    s_add_u32 s77, s76, 33792
    v_mfma_f32_16x16x32_bf16 v[10:13], a[44:47], v[156:159], v[10:13]
    v_mfma_f32_16x16x32_bf16 v[10:13], a[48:51], v[160:163], v[10:13]
    s_add_u32 s78, s76, 67584
    v_mfma_f32_16x16x32_bf16 v[10:13], a[52:55], v[164:167], v[10:13]
    buffer_load_dwordx4 v[248:251], v1, s[68:71], s72 offen offset:3072 sc1
    v_mfma_f32_16x16x32_bf16 v[10:13], a[56:59], v[168:171], v[10:13]
    s_add_u32 s72, s3, 3
    s_and_b32 s72, s72, 3
    s_mul_i32 s72, s72, 49152
    v_mfma_f32_16x16x32_bf16 v[10:13], a[60:63], v[172:175], v[10:13]
    s_mov_b32 s74, 0xbfb8aa3b
    s_add_u32 s72, s82, s72
    v_mfma_f32_16x16x32_bf16 v[14:17], a[246:249], v[252:255], 0
    v_mfma_f32_16x16x32_bf16 v[14:17], a[64:67], v[128:131], v[14:17]
    buffer_load_dwordx4 v[48:51], v1, s[68:71], s72 offen offset:0 sc1
    v_mfma_f32_16x16x32_bf16 v[14:17], a[68:71], v[132:135], v[14:17]
    v_mfma_f32_16x16x32_bf16 v[14:17], a[72:75], v[136:139], v[14:17]
    s_nop 0
    ds_write_addtid_b32 v10 offset:51200
    ds_write_addtid_b32 v11 offset:51456
    v_mfma_f32_16x16x32_bf16 v[14:17], a[76:79], v[140:143], v[14:17]
    ds_write_addtid_b32 v12 offset:51712
    ds_write_addtid_b32 v13 offset:51968
    v_mfma_f32_16x16x32_bf16 v[14:17], a[80:83], v[144:147], v[14:17]
    s_waitcnt vmcnt(9)
    s_mov_b64 exec, 1
    buffer_store_dword v232, off, s[68:71], s81 sc1
    s_mov_b64 exec, -1
    v_mfma_f32_16x16x32_bf16 v[14:17], a[84:87], v[148:151], v[14:17]
    buffer_load_dwordx4 v[52:55], v1, s[68:71], s72 offen offset:1024 sc1
    v_mfma_f32_16x16x32_bf16 v[14:17], a[88:91], v[152:155], v[14:17]
    v_mfma_f32_16x16x32_bf16 v[14:17], a[92:95], v[156:159], v[14:17]
    v_mfma_f32_16x16x32_bf16 v[14:17], a[96:99], v[160:163], v[14:17]
    v_mfma_f32_16x16x32_bf16 v[14:17], a[100:103], v[164:167], v[14:17]
    s_waitcnt lgkmcnt(0)
    s_barrier
    v_mfma_f32_16x16x32_bf16 v[14:17], a[104:107], v[168:171], v[14:17]
    buffer_load_dwordx4 v[56:59], v1, s[68:71], s72 offen offset:2048 sc1
    v_mfma_f32_16x16x32_bf16 v[14:17], a[108:111], v[172:175], v[14:17]
    ds_read2st64_b32 v[22:23], v217 offset0:0 offset1:1
    v_mfma_f32_16x16x32_bf16 v[18:21], a[248:251], v[252:255], 0
    ds_read2st64_b32 v[24:25], v217 offset0:2 offset1:3
    v_mfma_f32_16x16x32_bf16 v[18:21], a[112:115], v[128:131], v[18:21]
    ds_read2st64_b32 v[26:27], v217 offset0:4 offset1:5
    v_mfma_f32_16x16x32_bf16 v[18:21], a[116:119], v[132:135], v[18:21]
    buffer_load_dwordx4 v[60:63], v1, s[68:71], s72 offen offset:3072 sc1
    v_mfma_f32_16x16x32_bf16 v[18:21], a[120:123], v[136:139], v[18:21]
    s_add_u32 s72, s72, 4096
    ds_read2st64_b32 v[28:29], v217 offset0:6 offset1:7
    v_mfma_f32_16x16x32_bf16 v[18:21], a[124:127], v[140:143], v[18:21]
    ds_read2st64_b32 v[30:31], v217 offset0:8 offset1:9
    ds_read2st64_b32 v[32:33], v217 offset0:10 offset1:11
    v_mfma_f32_16x16x32_bf16 v[18:21], a[128:131], v[144:147], v[18:21]
    ds_write_addtid_b32 v14 offset:52224
    v_mfma_f32_16x16x32_bf16 v[18:21], a[132:135], v[148:151], v[18:21]
    ds_write_addtid_b32 v15 offset:52480
    ds_write_addtid_b32 v16 offset:52736
    ds_write_addtid_b32 v17 offset:52992
    v_mfma_f32_16x16x32_bf16 v[18:21], a[136:139], v[152:155], v[18:21]
    buffer_load_dwordx4 v[64:67], v1, s[68:71], s72 offen offset:0 sc1
    v_mfma_f32_16x16x32_bf16 v[18:21], a[140:143], v[156:159], v[18:21]
    v_mfma_f32_16x16x32_bf16 v[18:21], a[144:147], v[160:163], v[18:21]
    v_mfma_f32_16x16x32_bf16 v[18:21], a[148:151], v[164:167], v[18:21]
    v_mfma_f32_16x16x32_bf16 v[18:21], a[152:155], v[168:171], v[18:21]
    buffer_load_dwordx4 v[68:71], v1, s[68:71], s72 offen offset:1024 sc1
    v_mfma_f32_16x16x32_bf16 v[18:21], a[156:159], v[172:175], v[18:21]
    s_waitcnt lgkmcnt(7)
    v_mfma_f32_16x16x32_bf16 v[22:25], a[160:163], v[176:179], v[22:25]
    v_mfma_f32_16x16x32_bf16 v[22:25], a[164:167], v[180:183], v[22:25]
    v_mfma_f32_16x16x32_bf16 v[22:25], a[168:171], v[184:187], v[22:25]
    buffer_load_dwordx4 v[72:75], v1, s[68:71], s72 offen offset:2048 sc1
    v_mfma_f32_16x16x32_bf16 v[22:25], a[172:175], v[188:191], v[22:25]
    s_waitcnt vmcnt(15)
    s_nop 0
    ds_write_addtid_b32 v18 offset:53248
    ds_write_addtid_b32 v19 offset:53504
    v_mfma_f32_16x16x32_bf16 v[22:25], a[176:179], v[192:195], v[22:25]
    s_waitcnt vmcnt(14)
    ds_write_addtid_b32 v20 offset:53760
    ds_write_addtid_b32 v21 offset:54016
    v_mfma_f32_16x16x32_bf16 v[22:25], a[180:183], v[196:199], v[22:25]
    s_waitcnt vmcnt(13)
    v_mfma_f32_16x16x32_bf16 v[22:25], a[184:187], v[200:203], v[22:25]
    s_waitcnt vmcnt(12)
    v_mfma_f32_16x16x32_bf16 v[22:25], a[188:191], v[204:207], v[22:25]
    s_waitcnt vmcnt(11)
    v_mfma_f32_16x16x32_bf16 v[22:25], a[192:195], v[208:211], v[22:25]
    s_waitcnt vmcnt(10)
    v_mfma_f32_16x16x32_bf16 v[22:25], a[196:199], v[240:243], v[22:25]
    s_waitcnt vmcnt(9)
    v_mfma_f32_16x16x32_bf16 v[22:25], a[200:203], v[244:247], v[22:25]
    s_waitcnt vmcnt(8)
    s_waitcnt lgkmcnt(0)
    s_barrier
    v_mfma_f32_16x16x32_bf16 v[22:25], a[204:207], v[248:251], v[22:25]
    buffer_load_dwordx4 v[76:79], v1, s[68:71], s72 offen offset:3072 sc1
    v_mfma_f32_16x16x32_bf16 v[26:29], a[208:211], v[176:179], v[26:29]
    s_add_u32 s72, s72, 4096
    ds_read2st64_b32 v[34:35], v217 offset0:12 offset1:13
    v_mfma_f32_16x16x32_bf16 v[26:29], a[212:215], v[180:183], v[26:29]
    ds_read2st64_b32 v[36:37], v217 offset0:14 offset1:15
    v_mfma_f32_16x16x32_bf16 v[26:29], a[216:219], v[184:187], v[26:29]
    ds_read2st64_b32 v[38:39], v217 offset0:16 offset1:17
    v_mfma_f32_16x16x32_bf16 v[26:29], a[220:223], v[188:191], v[26:29]
    buffer_load_dwordx4 v[80:83], v1, s[68:71], s72 offen offset:0 sc1
    v_mfma_f32_16x16x32_bf16 v[26:29], a[224:227], v[192:195], v[26:29]
    ds_read2st64_b32 v[40:41], v217 offset0:18 offset1:19
    ds_write_addtid_b32 v22 offset:54272
    v_mfma_f32_16x16x32_bf16 v[26:29], a[228:231], v[196:199], v[26:29]
    ds_write_addtid_b32 v23 offset:54528
    ds_write_addtid_b32 v24 offset:54784
    v_mfma_f32_16x16x32_bf16 v[26:29], a[232:235], v[200:203], v[26:29]
    ds_write_addtid_b32 v25 offset:55040
    v_mfma_f32_16x16x32_bf16 v[26:29], a[236:239], v[204:207], v[26:29]
    buffer_load_dwordx4 v[84:87], v1, s[68:71], s72 offen offset:1024 sc1
    v_mfma_f32_16x16x32_bf16 v[26:29], a[0:3], v[208:211], v[26:29]
    v_mfma_f32_16x16x32_bf16 v[26:29], a[4:7], v[240:243], v[26:29]
    v_mfma_f32_16x16x32_bf16 v[26:29], a[8:11], v[244:247], v[26:29]
    v_mfma_f32_16x16x32_bf16 v[26:29], a[12:15], v[248:251], v[26:29]
    buffer_load_dwordx4 v[88:91], v1, s[68:71], s72 offen offset:2048 sc1
    v_mfma_f32_16x16x32_bf16 v[30:33], a[16:19], v[176:179], v[30:33]
    v_mfma_f32_16x16x32_bf16 v[30:33], a[20:23], v[180:183], v[30:33]
    v_mfma_f32_16x16x32_bf16 v[30:33], a[24:27], v[184:187], v[30:33]
    v_mfma_f32_16x16x32_bf16 v[30:33], a[28:31], v[188:191], v[30:33]
    buffer_load_dwordx4 v[92:95], v1, s[68:71], s72 offen offset:3072 sc1
    v_mfma_f32_16x16x32_bf16 v[30:33], a[32:35], v[192:195], v[30:33]
    s_add_u32 s72, s3, 4
    ds_write_addtid_b32 v26 offset:55296
    ds_write_addtid_b32 v27 offset:55552
    v_mfma_f32_16x16x32_bf16 v[30:33], a[36:39], v[196:199], v[30:33]
    s_and_b32 s72, s72, 3
    ds_write_addtid_b32 v28 offset:55808
    ds_write_addtid_b32 v29 offset:56064
    v_mfma_f32_16x16x32_bf16 v[30:33], a[40:43], v[200:203], v[30:33]
    s_mul_i32 s72, s72, 49152
    s_add_u32 s72, s82, s72
    v_mfma_f32_16x16x32_bf16 v[30:33], a[44:47], v[204:207], v[30:33]
    buffer_load_dwordx4 v[128:131], v1, s[68:71], s72 offen offset:0 sc1
    v_mfma_f32_16x16x32_bf16 v[30:33], a[48:51], v[208:211], v[30:33]
    v_mfma_f32_16x16x32_bf16 v[30:33], a[52:55], v[240:243], v[30:33]
    v_mfma_f32_16x16x32_bf16 v[30:33], a[56:59], v[244:247], v[30:33]
    v_mfma_f32_16x16x32_bf16 v[30:33], a[60:63], v[248:251], v[30:33]
    s_waitcnt lgkmcnt(4)
    v_mfma_f32_16x16x32_bf16 v[34:37], a[64:67], v[176:179], v[34:37]
    buffer_load_dwordx4 v[132:135], v1, s[68:71], s72 offen offset:1024 sc1
    v_mfma_f32_16x16x32_bf16 v[34:37], a[68:71], v[180:183], v[34:37]
    v_mfma_f32_16x16x32_bf16 v[34:37], a[72:75], v[184:187], v[34:37]
    ds_read_b64 v[96:97], v219 offset:0
    v_mfma_f32_16x16x32_bf16 v[34:37], a[76:79], v[188:191], v[34:37]
    s_nop 0
    ds_write_addtid_b32 v30 offset:56320
    ds_write_addtid_b32 v31 offset:56576
    v_mfma_f32_16x16x32_bf16 v[34:37], a[80:83], v[192:195], v[34:37]
    buffer_load_dwordx4 v[136:139], v1, s[68:71], s72 offen offset:2048 sc1
    v_mfma_f32_16x16x32_bf16 v[34:37], a[84:87], v[196:199], v[34:37]
    ds_write_addtid_b32 v32 offset:56832
    ds_write_addtid_b32 v33 offset:57088
    v_mfma_f32_16x16x32_bf16 v[34:37], a[88:91], v[200:203], v[34:37]
    ds_read_b64 v[98:99], v219 offset:32
    ds_read_b64 v[100:101], v219 offset:64
    v_mfma_f32_16x16x32_bf16 v[34:37], a[92:95], v[204:207], v[34:37]
    ds_read_b64 v[102:103], v219 offset:96
    v_mfma_f32_16x16x32_bf16 v[34:37], a[96:99], v[208:211], v[34:37]
    buffer_load_dwordx4 v[140:143], v1, s[68:71], s72 offen offset:3072 sc1
    v_mfma_f32_16x16x32_bf16 v[34:37], a[100:103], v[240:243], v[34:37]
    s_add_u32 s72, s72, 4096
    ds_read_b64 v[104:105], v219 offset:128
    v_mfma_f32_16x16x32_bf16 v[34:37], a[104:107], v[244:247], v[34:37]
    s_waitcnt lgkmcnt(4)
    s_barrier
    v_mfma_f32_16x16x32_bf16 v[34:37], a[108:111], v[248:251], v[34:37]
    ds_read2st64_b32 v[2:3], v217 offset0:20 offset1:21
    v_mfma_f32_16x16x32_bf16 v[38:41], a[112:115], v[176:179], v[38:41]
    buffer_load_dwordx4 v[144:147], v1, s[68:71], s72 offen offset:0 sc1
    v_mfma_f32_16x16x32_bf16 v[38:41], a[116:119], v[180:183], v[38:41]
    ds_read2st64_b32 v[4:5], v217 offset0:22 offset1:23
    v_mfma_f32_16x16x32_bf16 v[38:41], a[120:123], v[184:187], v[38:41]
    ds_read2st64_b32 v[6:7], v217 offset0:24 offset1:25
    v_mfma_f32_16x16x32_bf16 v[38:41], a[124:127], v[188:191], v[38:41]
    ds_read2st64_b32 v[8:9], v217 offset0:26 offset1:27
    v_mfma_f32_16x16x32_bf16 v[38:41], a[128:131], v[192:195], v[38:41]
    buffer_load_dwordx4 v[148:151], v1, s[68:71], s72 offen offset:1024 sc1
    v_mfma_f32_16x16x32_bf16 v[38:41], a[132:135], v[196:199], v[38:41]
    ds_read2st64_b32 v[10:11], v217 offset0:28 offset1:29
    ds_read2st64_b32 v[12:13], v217 offset0:30 offset1:31
    v_mfma_f32_16x16x32_bf16 v[38:41], a[136:139], v[200:203], v[38:41]
    ds_write_addtid_b32 v34 offset:57344
    ds_write_addtid_b32 v35 offset:57600
    ds_write_addtid_b32 v36 offset:57856
    ds_write_addtid_b32 v37 offset:58112
    v_mfma_f32_16x16x32_bf16 v[38:41], a[140:143], v[204:207], v[38:41]
    buffer_load_dwordx4 v[152:155], v1, s[68:71], s72 offen offset:2048 sc1
    v_mfma_f32_16x16x32_bf16 v[38:41], a[144:147], v[208:211], v[38:41]
    v_mfma_f32_16x16x32_bf16 v[38:41], a[148:151], v[240:243], v[38:41]
    v_mfma_f32_16x16x32_bf16 v[38:41], a[152:155], v[244:247], v[38:41]
    v_mfma_f32_16x16x32_bf16 v[38:41], a[156:159], v[248:251], v[38:41]
    s_waitcnt vmcnt(19) lgkmcnt(8)
    v_mfma_f32_16x16x32_bf16 v[2:5], a[160:163], v[48:51], v[2:5]
    s_waitcnt vmcnt(17)
    v_mfma_f32_16x16x32_bf16 v[2:5], a[164:167], v[52:55], v[2:5]
    s_waitcnt vmcnt(16)
    buffer_load_dword v233, v43, s[68:71], s86 offen sc1
    v_mfma_f32_16x16x32_bf16 v[2:5], a[168:171], v[56:59], v[2:5]
    s_waitcnt vmcnt(16)
    v_mfma_f32_16x16x32_bf16 v[2:5], a[172:175], v[60:63], v[2:5]
    s_waitcnt vmcnt(15)
    ds_write_addtid_b32 v38 offset:58368
    ds_write_addtid_b32 v39 offset:58624
    v_mfma_f32_16x16x32_bf16 v[2:5], a[176:179], v[64:67], v[2:5]
    s_waitcnt vmcnt(14)
    ds_write_addtid_b32 v40 offset:58880
    ds_write_addtid_b32 v41 offset:59136
    v_mfma_f32_16x16x32_bf16 v[2:5], a[180:183], v[68:71], v[2:5]
    s_waitcnt vmcnt(13)
    v_mfma_f32_16x16x32_bf16 v[2:5], a[184:187], v[72:75], v[2:5]
    s_waitcnt vmcnt(12)
    v_mfma_f32_16x16x32_bf16 v[2:5], a[188:191], v[76:79], v[2:5]
    s_waitcnt vmcnt(11)
    v_mfma_f32_16x16x32_bf16 v[2:5], a[192:195], v[80:83], v[2:5]
    s_waitcnt vmcnt(10)
    v_mfma_f32_16x16x32_bf16 v[2:5], a[196:199], v[84:87], v[2:5]
    s_waitcnt vmcnt(9)
    v_mfma_f32_16x16x32_bf16 v[2:5], a[200:203], v[88:91], v[2:5]
    s_waitcnt vmcnt(8)
    s_waitcnt lgkmcnt(0)
    s_barrier
    v_mfma_f32_16x16x32_bf16 v[2:5], a[204:207], v[92:95], v[2:5]
    buffer_load_dwordx4 v[156:159], v1, s[68:71], s72 offen offset:3072 sc1
    v_mfma_f32_16x16x32_bf16 v[6:9], a[208:211], v[48:51], v[6:9]
    s_add_u32 s72, s72, 4096
    ds_read2st64_b32 v[14:15], v217 offset0:32 offset1:33
    v_lshlrev_b32 v176, 16, v96
    v_mfma_f32_16x16x32_bf16 v[6:9], a[212:215], v[52:55], v[6:9]
    ds_read2st64_b32 v[16:17], v217 offset0:34 offset1:35
    v_mfma_f32_16x16x32_bf16 v[6:9], a[216:219], v[56:59], v[6:9]
    ds_read2st64_b32 v[18:19], v217 offset0:36 offset1:37
    v_mfma_f32_16x16x32_bf16 v[6:9], a[220:223], v[60:63], v[6:9]
    buffer_load_dwordx4 v[160:163], v1, s[68:71], s72 offen offset:0 sc1
    v_mfma_f32_16x16x32_bf16 v[6:9], a[224:227], v[64:67], v[6:9]
    ds_read2st64_b32 v[20:21], v217 offset0:38 offset1:39
    ds_write_addtid_b32 v2 offset:49152
    v_mfma_f32_16x16x32_bf16 v[6:9], a[228:231], v[68:71], v[6:9]
    ds_write_addtid_b32 v3 offset:49408
    ds_write_addtid_b32 v4 offset:49664
    v_mfma_f32_16x16x32_bf16 v[6:9], a[232:235], v[72:75], v[6:9]
    ds_write_addtid_b32 v5 offset:49920
    v_and_b32 v177, 0xffff0000, v96
    v_mfma_f32_16x16x32_bf16 v[6:9], a[236:239], v[76:79], v[6:9]
    buffer_load_dwordx4 v[164:167], v1, s[68:71], s72 offen offset:1024 sc1
    v_mfma_f32_16x16x32_bf16 v[6:9], a[0:3], v[80:83], v[6:9]
    v_lshlrev_b32 v178, 16, v97
    v_and_b32 v179, 0xffff0000, v97
    v_mfma_f32_16x16x32_bf16 v[6:9], a[4:7], v[84:87], v[6:9]
    v_lshlrev_b32 v180, 16, v98
    v_mfma_f32_16x16x32_bf16 v[6:9], a[8:11], v[88:91], v[6:9]
    v_mfma_f32_16x16x32_bf16 v[6:9], a[12:15], v[92:95], v[6:9]
    buffer_load_dwordx4 v[168:171], v1, s[68:71], s72 offen offset:2048 sc1
    v_mfma_f32_16x16x32_bf16 v[10:13], a[16:19], v[48:51], v[10:13]
    v_and_b32 v181, 0xffff0000, v98
    v_mfma_f32_16x16x32_bf16 v[10:13], a[20:23], v[52:55], v[10:13]
    v_mfma_f32_16x16x32_bf16 v[10:13], a[24:27], v[56:59], v[10:13]
    v_lshlrev_b32 v182, 16, v99
    v_mfma_f32_16x16x32_bf16 v[10:13], a[28:31], v[60:63], v[10:13]
    buffer_load_dwordx4 v[172:175], v1, s[68:71], s72 offen offset:3072 sc1
    v_mfma_f32_16x16x32_bf16 v[10:13], a[32:35], v[64:67], v[10:13]
    ds_write_addtid_b32 v6 offset:50176
    ds_write_addtid_b32 v7 offset:50432
    v_mfma_f32_16x16x32_bf16 v[10:13], a[36:39], v[68:71], v[10:13]
    ds_write_addtid_b32 v8 offset:50688
    ds_write_addtid_b32 v9 offset:50944
    v_mfma_f32_16x16x32_bf16 v[10:13], a[40:43], v[72:75], v[10:13]
    v_and_b32 v183, 0xffff0000, v99
    v_lshlrev_b32 v184, 16, v100
    v_mfma_f32_16x16x32_bf16 v[10:13], a[44:47], v[76:79], v[10:13]
    v_mfma_f32_16x16x32_bf16 v[10:13], a[48:51], v[80:83], v[10:13]
    v_and_b32 v185, 0xffff0000, v100
    v_mfma_f32_16x16x32_bf16 v[10:13], a[52:55], v[84:87], v[10:13]
    v_mfma_f32_16x16x32_bf16 v[10:13], a[56:59], v[88:91], v[10:13]
    v_lshlrev_b32 v186, 16, v101
    v_mfma_f32_16x16x32_bf16 v[10:13], a[60:63], v[92:95], v[10:13]
    s_waitcnt lgkmcnt(4)
    v_mfma_f32_16x16x32_bf16 v[14:17], a[64:67], v[48:51], v[14:17]
    v_and_b32 v187, 0xffff0000, v101
    v_mfma_f32_16x16x32_bf16 v[14:17], a[68:71], v[52:55], v[14:17]
    v_mfma_f32_16x16x32_bf16 v[14:17], a[72:75], v[56:59], v[14:17]
    v_mfma_f32_16x16x32_bf16 v[14:17], a[76:79], v[60:63], v[14:17]
    s_nop 1
    ds_write_addtid_b32 v10 offset:51200
    ds_write_addtid_b32 v11 offset:51456
    v_mfma_f32_16x16x32_bf16 v[14:17], a[80:83], v[64:67], v[14:17]
    ds_write_addtid_b32 v12 offset:51712
    ds_write_addtid_b32 v13 offset:51968
    v_mfma_f32_16x16x32_bf16 v[14:17], a[84:87], v[68:71], v[14:17]
    v_lshlrev_b32 v188, 16, v102
    v_and_b32 v189, 0xffff0000, v102
    v_mfma_f32_16x16x32_bf16 v[14:17], a[88:91], v[72:75], v[14:17]
    v_mfma_f32_16x16x32_bf16 v[14:17], a[92:95], v[76:79], v[14:17]
    v_lshlrev_b32 v190, 16, v103
    v_mfma_f32_16x16x32_bf16 v[14:17], a[96:99], v[80:83], v[14:17]
    v_mfma_f32_16x16x32_bf16 v[14:17], a[100:103], v[84:87], v[14:17]
    v_and_b32 v191, 0xffff0000, v103
    v_mfma_f32_16x16x32_bf16 v[14:17], a[104:107], v[88:91], v[14:17]
    s_waitcnt lgkmcnt(0)
    s_barrier
    v_mfma_f32_16x16x32_bf16 v[14:17], a[108:111], v[92:95], v[14:17]
    ds_read2st64_b32 v[22:23], v217 offset0:0 offset1:1
    v_lshlrev_b32 v192, 16, v104
    v_mfma_f32_16x16x32_bf16 v[18:21], a[112:115], v[48:51], v[18:21]
    ds_read2st64_b32 v[24:25], v217 offset0:2 offset1:3
    v_mfma_f32_16x16x32_bf16 v[18:21], a[116:119], v[52:55], v[18:21]
    ds_read2st64_b32 v[26:27], v217 offset0:4 offset1:5
    v_mfma_f32_16x16x32_bf16 v[18:21], a[120:123], v[56:59], v[18:21]
    ds_read2st64_b32 v[28:29], v217 offset0:6 offset1:7
    v_and_b32 v193, 0xffff0000, v104
    v_mfma_f32_16x16x32_bf16 v[18:21], a[124:127], v[60:63], v[18:21]
    ds_read2st64_b32 v[30:31], v217 offset0:8 offset1:9
    v_mfma_f32_16x16x32_bf16 v[18:21], a[128:131], v[64:67], v[18:21]
    ds_read2st64_b32 v[32:33], v217 offset0:10 offset1:11
    ds_write_addtid_b32 v14 offset:52224
    v_mfma_f32_16x16x32_bf16 v[18:21], a[132:135], v[68:71], v[18:21]
    ds_write_addtid_b32 v15 offset:52480
    ds_write_addtid_b32 v16 offset:52736
    v_mfma_f32_16x16x32_bf16 v[18:21], a[136:139], v[72:75], v[18:21]
    ds_write_addtid_b32 v17 offset:52992
    v_lshlrev_b32 v194, 16, v105
    v_mfma_f32_16x16x32_bf16 v[18:21], a[140:143], v[76:79], v[18:21]
    s_waitcnt vmcnt(5)
    v_cmp_ne_u32 vcc, s50, v233
    s_nop 0
    s_cmp_lg_u64 vcc, 0
    s_cbranch_scc1 L_slow_s
L_ok_s:
    v_mfma_f32_16x16x32_bf16 v[18:21], a[144:147], v[80:83], v[18:21]
    buffer_load_dwordx4 v[116:119], v44, s[68:71], s76 offen sc1
    v_mfma_f32_16x16x32_bf16 v[18:21], a[148:151], v[84:87], v[18:21]
    v_and_b32 v195, 0xffff0000, v105
    v_mov_b32 v206, s74
    v_mfma_f32_16x16x32_bf16 v[18:21], a[152:155], v[88:91], v[18:21]
    v_mov_b32 v207, 1.0
    v_mfma_f32_16x16x32_bf16 v[18:21], a[156:159], v[92:95], v[18:21]
    s_waitcnt lgkmcnt(7)
    v_mfma_f32_16x16x32_bf16 v[22:25], a[160:163], v[128:131], v[22:25]
    buffer_load_dwordx4 v[120:123], v44, s[68:71], s77 offen sc1
    buffer_load_dwordx4 v[124:127], v46, s[68:71], s78 offen sc1
    v_mfma_f32_16x16x32_bf16 v[22:25], a[164:167], v[132:135], v[22:25]
    v_mfma_f32_16x16x32_bf16 v[22:25], a[168:171], v[136:139], v[22:25]
    v_mfma_f32_16x16x32_bf16 v[22:25], a[172:175], v[140:143], v[22:25]
    s_nop 0
    ds_write_addtid_b32 v18 offset:53248
    ds_write_addtid_b32 v19 offset:53504
    v_mfma_f32_16x16x32_bf16 v[22:25], a[176:179], v[144:147], v[22:25]
    ds_write_addtid_b32 v20 offset:53760
    ds_write_addtid_b32 v21 offset:54016
    v_mfma_f32_16x16x32_bf16 v[22:25], a[180:183], v[148:151], v[22:25]
    v_mfma_f32_16x16x32_bf16 v[22:25], a[184:187], v[152:155], v[22:25]
    s_waitcnt vmcnt(7)
    v_mfma_f32_16x16x32_bf16 v[22:25], a[188:191], v[156:159], v[22:25]
    s_waitcnt vmcnt(6)
    v_mfma_f32_16x16x32_bf16 v[22:25], a[192:195], v[160:163], v[22:25]
    s_waitcnt vmcnt(5)
    v_mfma_f32_16x16x32_bf16 v[22:25], a[196:199], v[164:167], v[22:25]
    s_waitcnt vmcnt(4)
    v_mfma_f32_16x16x32_bf16 v[22:25], a[200:203], v[168:171], v[22:25]
    s_waitcnt vmcnt(3)
    s_waitcnt lgkmcnt(0)
    s_barrier
    v_mfma_f32_16x16x32_bf16 v[22:25], a[204:207], v[172:175], v[22:25]
    ds_read2st64_b32 v[34:35], v217 offset0:12 offset1:13
    v_mfma_f32_16x16x32_bf16 v[26:29], a[208:211], v[128:131], v[26:29]
    ds_read2st64_b32 v[36:37], v217 offset0:14 offset1:15
    v_mfma_f32_16x16x32_bf16 v[26:29], a[212:215], v[132:135], v[26:29]
    ds_read2st64_b32 v[38:39], v217 offset0:16 offset1:17
    v_mfma_f32_16x16x32_bf16 v[26:29], a[216:219], v[136:139], v[26:29]
    ds_read2st64_b32 v[40:41], v217 offset0:18 offset1:19
    s_nop 0
    v_mul_f32 v200, s74, v22
    v_mfma_f32_16x16x32_bf16 v[26:29], a[220:223], v[140:143], v[26:29]
    v_mul_f32 v201, s74, v23
    v_mul_f32 v202, s74, v24
    v_mfma_f32_16x16x32_bf16 v[26:29], a[224:227], v[144:147], v[26:29]
    v_mul_f32 v203, s74, v25
    v_mfma_f32_16x16x32_bf16 v[26:29], a[228:231], v[148:151], v[26:29]
    v_exp_f32 v200, v200
    v_mfma_f32_16x16x32_bf16 v[26:29], a[232:235], v[152:155], v[26:29]
    v_exp_f32 v201, v201
    v_mfma_f32_16x16x32_bf16 v[26:29], a[236:239], v[156:159], v[26:29]
    v_exp_f32 v202, v202
    v_mfma_f32_16x16x32_bf16 v[26:29], a[0:3], v[160:163], v[26:29]
    v_exp_f32 v203, v203
    v_mfma_f32_16x16x32_bf16 v[26:29], a[4:7], v[164:167], v[26:29]
    v_add_f32 v200, 1.0, v200
    v_add_f32 v201, 1.0, v201
    v_mfma_f32_16x16x32_bf16 v[26:29], a[8:11], v[168:171], v[26:29]
    v_add_f32 v202, 1.0, v202
    v_add_f32 v203, 1.0, v203
    v_mfma_f32_16x16x32_bf16 v[26:29], a[12:15], v[172:175], v[26:29]
    v_rcp_f32 v200, v200
    v_mfma_f32_16x16x32_bf16 v[30:33], a[16:19], v[128:131], v[30:33]
    v_rcp_f32 v201, v201
    v_mfma_f32_16x16x32_bf16 v[30:33], a[20:23], v[132:135], v[30:33]
    v_rcp_f32 v202, v202
    v_mfma_f32_16x16x32_bf16 v[30:33], a[24:27], v[136:139], v[30:33]
    v_rcp_f32 v203, v203
    v_mfma_f32_16x16x32_bf16 v[30:33], a[28:31], v[140:143], v[30:33]
    v_mul_f32 v22, v22, v200
    v_mul_f32 v23, v23, v201
    v_mfma_f32_16x16x32_bf16 v[30:33], a[32:35], v[144:147], v[30:33]
    v_mul_f32 v24, v24, v202
    v_mul_f32 v25, v25, v203
    v_mfma_f32_16x16x32_bf16 v[30:33], a[36:39], v[148:151], v[30:33]
    v_mul_f32 v200, s74, v26
    v_mul_f32 v201, s74, v27
    v_mfma_f32_16x16x32_bf16 v[30:33], a[40:43], v[152:155], v[30:33]
    v_mul_f32 v202, s74, v28
    v_mul_f32 v203, s74, v29
    v_mfma_f32_16x16x32_bf16 v[30:33], a[44:47], v[156:159], v[30:33]
    v_exp_f32 v200, v200
    v_mfma_f32_16x16x32_bf16 v[30:33], a[48:51], v[160:163], v[30:33]
    v_exp_f32 v201, v201
    v_mfma_f32_16x16x32_bf16 v[30:33], a[52:55], v[164:167], v[30:33]
    v_exp_f32 v202, v202
    v_mfma_f32_16x16x32_bf16 v[30:33], a[56:59], v[168:171], v[30:33]
    v_exp_f32 v203, v203
    v_mfma_f32_16x16x32_bf16 v[30:33], a[60:63], v[172:175], v[30:33]
    s_waitcnt lgkmcnt(0)
    v_add_f32 v200, 1.0, v200
    v_mfma_f32_16x16x32_bf16 v[34:37], a[64:67], v[128:131], v[34:37]
    v_add_f32 v201, 1.0, v201
    v_mfma_f32_16x16x32_bf16 v[34:37], a[68:71], v[132:135], v[34:37]
    v_add_f32 v202, 1.0, v202
    v_mfma_f32_16x16x32_bf16 v[34:37], a[72:75], v[136:139], v[34:37]
    v_add_f32 v203, 1.0, v203
    v_mfma_f32_16x16x32_bf16 v[34:37], a[76:79], v[140:143], v[34:37]
    v_rcp_f32 v200, v200
    v_mfma_f32_16x16x32_bf16 v[34:37], a[80:83], v[144:147], v[34:37]
    v_rcp_f32 v201, v201
    v_mfma_f32_16x16x32_bf16 v[34:37], a[84:87], v[148:151], v[34:37]
    v_mfma_f32_16x16x32_bf16 v[34:37], a[88:91], v[152:155], v[34:37]
    v_rcp_f32 v202, v202
    v_mfma_f32_16x16x32_bf16 v[34:37], a[92:95], v[156:159], v[34:37]
    v_mfma_f32_16x16x32_bf16 v[34:37], a[96:99], v[160:163], v[34:37]
    v_rcp_f32 v203, v203
    v_mfma_f32_16x16x32_bf16 v[34:37], a[100:103], v[164:167], v[34:37]
    s_waitcnt vmcnt(2)
    ds_write_b128 v214, v[116:119] offset:0
    v_mfma_f32_16x16x32_bf16 v[34:37], a[104:107], v[168:171], v[34:37]
    v_mul_f32 v26, v26, v200
    v_mul_f32 v27, v27, v201
    v_mfma_f32_16x16x32_bf16 v[34:37], a[108:111], v[172:175], v[34:37]
    v_mul_f32 v28, v28, v202
    v_mfma_f32_16x16x32_bf16 v[38:41], a[112:115], v[128:131], v[38:41]
    v_mul_f32 v29, v29, v203
    v_mfma_f32_16x16x32_bf16 v[38:41], a[116:119], v[132:135], v[38:41]
    s_waitcnt vmcnt(1)
    ds_write_b128 v214, v[120:123] offset:256
    v_mfma_f32_16x16x32_bf16 v[38:41], a[120:123], v[136:139], v[38:41]
    v_mfma_f32_16x16x32_bf16 v[38:41], a[124:127], v[140:143], v[38:41]
    v_mfma_f32_16x16x32_bf16 v[38:41], a[128:131], v[144:147], v[38:41]
    v_mfma_f32_16x16x32_bf16 v[38:41], a[132:135], v[148:151], v[38:41]
    s_waitcnt vmcnt(0)
    ds_write_b128 v47, v[124:127] offset:512
    v_mfma_f32_16x16x32_bf16 v[38:41], a[136:139], v[152:155], v[38:41]
    v_mfma_f32_16x16x32_bf16 v[38:41], a[140:143], v[156:159], v[38:41]
    v_mfma_f32_16x16x32_bf16 v[38:41], a[144:147], v[160:163], v[38:41]
    v_mfma_f32_16x16x32_bf16 v[38:41], a[148:151], v[164:167], v[38:41]
    s_waitcnt lgkmcnt(0)
    s_barrier
    ds_read_b64_tr_b16 v[106:107], v220 offset:0
    v_mfma_f32_16x16x32_bf16 v[38:41], a[152:155], v[168:171], v[38:41]
    ds_read_b64_tr_b16 v[108:109], v220 offset:512
    ds_read_b64_tr_b16 v[110:111], v220 offset:1024
    v_mfma_f32_16x16x32_bf16 v[38:41], a[156:159], v[172:175], v[38:41]
    ds_read_b64_tr_b16 v[112:113], v220 offset:1536
    ds_read_b64_tr_b16 v[114:115], v220 offset:2048
    v_pk_mul_f32 v[200:201], v[30:31], v[206:207] op_sel_hi:[1,0]
    v_pk_mul_f32 v[202:203], v[32:33], v[206:207] op_sel_hi:[1,0]
    v_exp_f32 v200, v200
    v_exp_f32 v201, v201
    v_exp_f32 v202, v202
    v_exp_f32 v203, v203
    v_pk_add_f32 v[200:201], v[200:201], v[206:207] op_sel:[0,1]
    v_pk_add_f32 v[202:203], v[202:203], v[206:207] op_sel:[0,1]
    v_rcp_f32 v200, v200
    v_rcp_f32 v201, v201
    v_rcp_f32 v202, v202
    v_rcp_f32 v203, v203
    v_pk_mul_f32 v[30:31], v[30:31], v[200:201]
    v_pk_mul_f32 v[32:33], v[32:33], v[202:203]
    v_pk_mul_f32 v[200:201], v[34:35], v[206:207] op_sel_hi:[1,0]
    v_pk_mul_f32 v[202:203], v[36:37], v[206:207] op_sel_hi:[1,0]
    v_exp_f32 v200, v200
    v_exp_f32 v201, v201
    v_exp_f32 v202, v202
    v_exp_f32 v203, v203
    v_pk_add_f32 v[200:201], v[200:201], v[206:207] op_sel:[0,1]
    v_pk_add_f32 v[202:203], v[202:203], v[206:207] op_sel:[0,1]
    v_rcp_f32 v200, v200
    v_rcp_f32 v201, v201
    v_rcp_f32 v202, v202
    v_rcp_f32 v203, v203
    v_pk_mul_f32 v[34:35], v[34:35], v[200:201]
    v_pk_mul_f32 v[36:37], v[36:37], v[202:203]
    s_waitcnt lgkmcnt(4)
    v_lshlrev_b32 v204, 16, v106
    v_and_b32 v205, 0xffff0000, v106
    v_pk_fma_f32 v[204:205], v[204:205], v[22:23], v[176:177]
    v_cvt_pk_bf16_f32 v96, v204, v205
    v_lshlrev_b32_e64 v204, 16, v107
    v_and_b32 v205, 0xffff0000, v107
    v_pk_fma_f32 v[204:205], v[204:205], v[24:25], v[178:179]
    v_cvt_pk_bf16_f32 v97, v204, v205
    s_waitcnt lgkmcnt(3)
    v_lshlrev_b32 v204, 16, v108
    v_and_b32 v205, 0xffff0000, v108
    v_pk_fma_f32 v[204:205], v[204:205], v[26:27], v[180:181]
    v_cvt_pk_bf16_f32 v98, v204, v205
    v_lshlrev_b32_e64 v204, 16, v109
    v_and_b32 v205, 0xffff0000, v109
    v_pk_fma_f32 v[204:205], v[204:205], v[28:29], v[182:183]
    v_cvt_pk_bf16_f32 v99, v204, v205
    s_waitcnt lgkmcnt(2)
    v_lshlrev_b32 v204, 16, v110
    v_and_b32 v205, 0xffff0000, v110
    v_pk_fma_f32 v[204:205], v[204:205], v[30:31], v[184:185]
    v_cvt_pk_bf16_f32 v100, v204, v205
    v_lshlrev_b32_e64 v204, 16, v111
    v_and_b32 v205, 0xffff0000, v111
    v_pk_fma_f32 v[204:205], v[204:205], v[32:33], v[186:187]
    v_cvt_pk_bf16_f32 v101, v204, v205
    s_waitcnt lgkmcnt(1)
    v_lshlrev_b32 v204, 16, v112
    v_and_b32 v205, 0xffff0000, v112
    v_pk_fma_f32 v[204:205], v[204:205], v[34:35], v[188:189]
    v_cvt_pk_bf16_f32 v102, v204, v205
    v_lshlrev_b32_e64 v204, 16, v113
    v_and_b32 v205, 0xffff0000, v113
    v_pk_fma_f32 v[204:205], v[204:205], v[36:37], v[190:191]
    v_cvt_pk_bf16_f32 v103, v204, v205
    ds_write_b64 v219, v[96:97] offset:0
    ds_write_b64 v219, v[98:99] offset:32
    ds_write_b64 v219, v[100:101] offset:64
    ds_write_b64 v219, v[102:103] offset:96
    v_pk_mul_f32 v[200:201], v[38:39], v[206:207] op_sel_hi:[1,0]
    v_pk_mul_f32 v[202:203], v[40:41], v[206:207] op_sel_hi:[1,0]
    v_exp_f32 v200, v200
    v_exp_f32 v201, v201
    v_exp_f32 v202, v202
    v_exp_f32 v203, v203
    v_pk_add_f32 v[200:201], v[200:201], v[206:207] op_sel:[0,1]
    v_pk_add_f32 v[202:203], v[202:203], v[206:207] op_sel:[0,1]
    v_rcp_f32 v200, v200
    v_rcp_f32 v201, v201
    v_rcp_f32 v202, v202
    v_rcp_f32 v203, v203
    v_pk_mul_f32 v[38:39], v[38:39], v[200:201]
    v_pk_mul_f32 v[40:41], v[40:41], v[202:203]
    s_waitcnt lgkmcnt(4)
    v_lshlrev_b32 v204, 16, v114
    v_and_b32 v205, 0xffff0000, v114
    v_pk_fma_f32 v[204:205], v[204:205], v[38:39], v[192:193]
    v_cvt_pk_bf16_f32 v104, v204, v205
    v_lshlrev_b32_e64 v204, 16, v115
    v_and_b32 v205, 0xffff0000, v115
    v_pk_fma_f32 v[204:205], v[204:205], v[40:41], v[194:195]
    v_cvt_pk_bf16_f32 v105, v204, v205
    ds_write_b64 v219, v[104:105] offset:128
    s_nop 3
    ds_read_b128 v[116:119], v218 offset:0
    ds_read_b128 v[120:123], v218 offset:1024
    ds_read_b128 v[124:127], v218 offset:2048
    s_waitcnt lgkmcnt(2)
    buffer_store_dwordx4 v[116:119], v229, s[64:67], s14 offen nt
    s_waitcnt lgkmcnt(1)
    buffer_store_dwordx4 v[120:123], v230, s[64:67], s14 offen nt
    s_waitcnt lgkmcnt(0)
    buffer_store_dwordx4 v[124:127], v231, s[64:67], s14 offen nt
    s_or_b32 s7, s2, s3
    s_cbranch_scc1 L_fin
    s_mov_b32 s7, 16777216
    s_mov_b64 exec, 1
    buffer_store_dword v232, off, s[68:71], s7 sc1
    s_mov_b64 exec, -1
L_fin:
L_end:
    s_endpgm
L_slow_y0:
    s_mov_b32 s87, 0
L_spin_y0:
    buffer_load_dword v2, v209, s[68:71], s86 offen sc1
    s_add_u32 s87, s87, 1
    s_cmp_gt_u32 s87, 0x40000
    s_waitcnt vmcnt(0)
    s_cbranch_scc1 L_ok_y0
    v_cmp_ne_u32 vcc, s50, v2
    s_nop 0
    s_cmp_lg_u64 vcc, 0
    s_cbranch_scc1 L_spin_y0
    s_branch L_ok_y0
L_slow_y3:
    s_mov_b32 s87, 0
L_spin_y3:
    buffer_load_dword v4, v209, s[68:71], s86 offen sc1
    s_add_u32 s87, s87, 1
    s_cmp_gt_u32 s87, 0x40000
    s_waitcnt vmcnt(0)
    s_cbranch_scc1 L_ok_y3
    v_cmp_ne_u32 vcc, s50, v4
    s_nop 0
    s_cmp_lg_u64 vcc, 0
    s_cbranch_scc1 L_spin_y3
    s_branch L_ok_y3
L_slow_x:
    s_mov_b32 s87, 0
L_spin_x:
    s_sleep 12
    buffer_load_dwordx4 v[2:5], v208, s[68:71], s84 offen sc1
    s_add_u32 s87, s87, 1
    s_cmp_gt_u32 s87, 0x40000
    s_waitcnt vmcnt(0)
    s_cbranch_scc1 L_ok_x
    v_cmp_ne_u64 vcc, s[50:51], v[2:3]
    v_cmp_ne_u64 s[88:89], s[50:51], v[4:5]
    s_nop 0
    s_or_b64 vcc, vcc, s[88:89]
    s_cbranch_scc1 L_spin_x
    s_branch L_ok_x
L_slow_h0:
    s_mov_b32 s87, 0
L_spin_h0:
    buffer_load_dword v233, v42, s[68:71], s86 offen sc1
    s_add_u32 s87, s87, 1
    s_cmp_gt_u32 s87, 0x40000
    s_waitcnt vmcnt(0)
    s_cbranch_scc1 L_ok_h0
    v_cmp_ne_u32 vcc, s50, v233
    s_nop 0
    s_cmp_lg_u64 vcc, 0
    s_cbranch_scc1 L_spin_h0
    s_branch L_ok_h0
L_slow_h1:
    s_mov_b32 s87, 0
L_spin_h1:
    buffer_load_dword v233, v42, s[68:71], s86 offen sc1
    s_add_u32 s87, s87, 1
    s_cmp_gt_u32 s87, 0x40000
    s_waitcnt vmcnt(0)
    s_cbranch_scc1 L_ok_h1
    v_cmp_ne_u32 vcc, s50, v233
    s_nop 0
    s_cmp_lg_u64 vcc, 0
    s_cbranch_scc1 L_spin_h1
    s_branch L_ok_h1
L_slow_s:
    s_mov_b32 s87, 0
L_spin_s:
    buffer_load_dword v233, v43, s[68:71], s86 offen sc1
    s_add_u32 s87, s87, 1
    s_cmp_gt_u32 s87, 0x40000
    s_waitcnt vmcnt(0)
    s_cbranch_scc1 L_ok_s
    v_cmp_ne_u32 vcc, s50, v233
    s_nop 0
    s_cmp_lg_u64 vcc, 0
    s_cbranch_scc1 L_spin_s
    s_branch L_ok_s
L_code_end:
.section .rodata,"a"
.p2align 6
.amdhsa_kernel recurrent_scan__ssm_conv_s4__mixer_channel_mlp__prompt_kernel
  .amdhsa_next_free_vgpr 512
  .amdhsa_next_free_sgpr 102
  .amdhsa_accum_offset 256
  .amdhsa_group_segment_fixed_size 0
  .amdhsa_kernarg_size 136
  .amdhsa_user_sgpr_count 2
  .amdhsa_user_sgpr_kernarg_segment_ptr 1
  .amdhsa_system_sgpr_workgroup_id_x 1
.end_amdhsa_kernel
```
